```python
import torch

def _softmax(x, axis=-1):
    return torch.softmax(x, dim=axis)
def _gelu(x):
    return torch.nn.functional.gelu(x, approximate="tanh")
def _silu(x):
    return torch.nn.functional.silu(x)
def _sigmoid(x):
    return torch.sigmoid(x)
def _layernorm(x, axis=-1, eps=1e-5):
    m = x.mean(dim=axis, keepdim=True)
    v = x.var(dim=axis, keepdim=True, unbiased=False)
    return (x - m) / torch.sqrt(v + eps)
def _scatter_add(tgt, idx, src, axis=0):
    return tgt.clone().index_add_(axis, idx, src)
def _segment_sum(src, seg, n):
    out = torch.zeros((n,) + src.shape[1:], dtype=src.dtype)
    return out.index_add_(0, seg, src)
def _pad(x, pw):
    flat = tuple(v for pair in reversed(pw) for v in pair)
    return torch.nn.functional.pad(x, flat)

kernel_name = 'gated_mix__ssm_conv_s4d__mixer_channel_mlp__prompt'

def setup_inputs():

    _w = (lambda a: (lambda t: t.to(torch.bfloat16) if t.is_floating_point() else t)(torch.as_tensor(a)))
    def _A_setup():
        Bsz, L, D, N = 1, 2048, 640, 128
        return {
            "u": _w((lambda *s: torch.randn(*s, dtype=torch.bfloat16) * 0.05)(Bsz, L, D)),
            "log_A_real": _w((lambda *s: torch.randn(*s, dtype=torch.bfloat16) * 3.2)(D, N) * 0.5),
            "A_imag": _w((lambda *s: torch.randn(*s, dtype=torch.bfloat16) * 0.1)(D, N) * 3.14),
            "C_real": _w((lambda *s: torch.randn(*s, dtype=torch.bfloat16) * 0.8)(D, N) / N ** 0.5),
            "C_imag": _w((lambda *s: torch.randn(*s, dtype=torch.bfloat16) * 0.8)(D, N) / N ** 0.5),
            "log_dt": _w((lambda *s: torch.randn(*s, dtype=torch.bfloat16) * 0.1)(D) * 0.5 - 4.0),
            "D_skip": _w((lambda *s: torch.randn(*s, dtype=torch.bfloat16) * 0.1)(D)),
        }
    _A_in = _A_setup()

    def _B_setup():
        B, S, D, F = 1, 2048, 640, 1728
        return {
            "x": _w((lambda *s: torch.randn(*s, dtype=torch.bfloat16) * 0.05)(B, S, D)),
            "w1": _w((lambda *s: torch.randn(*s, dtype=torch.bfloat16) * 0.8)(D, F) * (D ** -0.5)),
            "b1": _w((lambda *s: torch.randn(*s, dtype=torch.bfloat16) * 0.4)(F)),
            "w2": _w((lambda *s: torch.randn(*s, dtype=torch.bfloat16) * 0.05)(F, D) * (F ** -0.5)),
            "b2": _w((lambda *s: torch.randn(*s, dtype=torch.bfloat16) * 0.05)(D)),
        }
    _B_in = _B_setup()

    return {
        "A_u": _A_in["u"],
        "A_log_A_real": _A_in["log_A_real"],
        "A_A_imag": _A_in["A_imag"],
        "A_C_real": _A_in["C_real"],
        "A_C_imag": _A_in["C_imag"],
        "A_log_dt": _A_in["log_dt"],
        "A_D_skip": _A_in["D_skip"],
        "B_x": _B_in["x"],
        "B_w1": _B_in["w1"],
        "B_b1": _B_in["b1"],
        "B_w2": _B_in["w2"],
        "B_b2": _B_in["b2"],
        "gate_w": _w((lambda *s: torch.randn(*s, dtype=torch.bfloat16) * 0.05)(640) * 16.0),
    }

def reference(A_u, A_log_A_real, A_A_imag, A_C_real, A_C_imag, A_log_dt, A_D_skip, B_x, B_w1, B_b1, B_w2, B_b2, gate_w):
    def _A_ref(u, log_A_real, A_imag, C_real, C_imag, log_dt, D_skip):
        L = u.shape[1]
        dt = torch.exp(log_dt)
        A = -torch.exp(log_A_real) + 1j * A_imag
        C = (C_real + 1j * C_imag) * dt[:, None]
        pos = (lambda x, dt: x.to(dt))(torch.arange(L), log_dt.dtype)
        P = torch.exp((A * dt[:, None])[:, :, None] * pos[None, None, :])
        K = 2.0 * torch.einsum("dn,dnl->dl", C, P).real
        L2 = 2 * L
        u_t = (lambda x, *d: x.permute(*d))(u, 0, 2, 1)
        Kf = (lambda x, *a, **k: torch.fft.rfft(x.float(), *a, **k))(K, L2)
        Uf = (lambda x, *a, **k: torch.fft.rfft(x.float(), *a, **k))(u_t, L2)
        y = (lambda x, *a, **k: torch.fft.irfft(x, *a, **k).to(torch.bfloat16))(Uf * Kf[None, :, :], L2)[:, :, :L]
        y = (lambda x, *d: x.permute(*d))(y, 0, 2, 1)
        return y + u * D_skip[None, None, :]

    def _B_ref(x, w1, b1, w2, b2):
        y = _layernorm(x, axis=-1)
        h = _gelu(torch.einsum("bsd,df->bsf", y, w1) + b1)
        return torch.einsum("bsf,fd->bsd", h, w2) + b2

    x = A_u
    g = _sigmoid((x * gate_w).sum(-1, keepdims=True))
    a = _A_ref(x, A_log_A_real, A_A_imag, A_C_real, A_C_imag, A_log_dt, A_D_skip)
    b = _B_ref(x, B_w1, B_b1, B_w2, B_b2)
    return g * a + (1 - g) * b
```

```asm
; @launch grid=(256,1,1) block=(512,1,1) lds=163840
.amdgcn_target "amdgcn-amd-amdhsa--gfx950"
.text
.globl gated_mix__ssm_conv_s4d__mixer_channel_mlp__prompt_kernel
.p2align 8
.type gated_mix__ssm_conv_s4d__mixer_channel_mlp__prompt_kernel,@function
gated_mix__ssm_conv_s4d__mixer_channel_mlp__prompt_kernel:
    s_cmp_ge_u32 s2, 256
    s_cbranch_scc1 L_end
    s_load_dwordx16 s[4:19], s[0:1], 0
    s_load_dwordx16 s[20:35], s[0:1], 64
    v_lshrrev_b32 v1, 6, v0
    v_and_b32 v127, 63, v0
    v_readfirstlane_b32 s3, v1
    s_cmp_ge_u32 s2, 32
    s_cbranch_scc1 L_norm
    s_lshr_b32 s70, s2, 3
    s_cmp_eq_u32 s3, 7
    s_cbranch_scc1 L_zf
    s_branch L_norm
L_zf:
    s_and_b32 s84, s2, 7
    s_lshl_b32 s84, s84, 2
    s_add_u32 s84, s84, s70
    v_mov_b32 v0, 0
    v_mov_b32 v1, 0
    v_mov_b32 v2, 0
    v_mov_b32 v3, 0
    v_lshlrev_b32 v4, 4, v127
    s_lshl_b32 s66, s84, 10
    s_add_u32 s66, s66, 16384
    s_mul_i32 s67, s84, 12288
    s_add_u32 s67, s67, 2752512
    s_lshl_b32 s69, s84, 2
    v_mov_b32 v5, s69
    v_mov_b32 v6, 1
    s_waitcnt lgkmcnt(0)
    s_mov_b32 s44, s34
    s_mov_b32 s45, s35
    s_mov_b32 s46, 16777216
    s_mov_b32 s47, 0x20000
    buffer_store_dwordx4 v[0:3], v4, s[44:47], s66 offen sc0 sc1
    buffer_store_dwordx4 v[0:3], v4, s[44:47], s67 offen offset:0 sc0 sc1
    buffer_store_dwordx4 v[0:3], v4, s[44:47], s67 offen offset:1024 sc0 sc1
    buffer_store_dwordx4 v[0:3], v4, s[44:47], s67 offen offset:2048 sc0 sc1
    buffer_store_dwordx4 v[0:3], v4, s[44:47], s67 offen offset:3072 sc0 sc1
    s_add_u32 s67, s67, 4096
    buffer_store_dwordx4 v[0:3], v4, s[44:47], s67 offen offset:0 sc0 sc1
    buffer_store_dwordx4 v[0:3], v4, s[44:47], s67 offen offset:1024 sc0 sc1
    buffer_store_dwordx4 v[0:3], v4, s[44:47], s67 offen offset:2048 sc0 sc1
    buffer_store_dwordx4 v[0:3], v4, s[44:47], s67 offen offset:3072 sc0 sc1
    s_add_u32 s67, s67, 4096
    buffer_store_dwordx4 v[0:3], v4, s[44:47], s67 offen offset:0 sc0 sc1
    buffer_store_dwordx4 v[0:3], v4, s[44:47], s67 offen offset:1024 sc0 sc1
    buffer_store_dwordx4 v[0:3], v4, s[44:47], s67 offen offset:2048 sc0 sc1
    buffer_store_dwordx4 v[0:3], v4, s[44:47], s67 offen offset:3072 sc0 sc1
    s_add_u32 s67, s67, 4096
    s_waitcnt vmcnt(0)
    s_mov_b64 exec, 1
    global_store_dword v5, v6, s[32:33] sc0 sc1
    s_mov_b64 exec, -1
L_norm:
    s_and_b32 s52, s2, 7
    s_lshr_b32 s53, s2, 3
    s_add_u32 s53, s53, 28
    s_and_b32 s53, s53, 31
    s_and_b32 s54, s53, 3
    s_lshr_b32 s55, s53, 2
    s_lshr_b32 s56, s52, 1
    s_lshl_b32 s56, s56, 2
    s_add_u32 s56, s56, s54
    s_and_b32 s57, s52, 1
    s_mul_i32 s58, s57, 7
    s_add_u32 s58, s58, s55
    s_add_u32 s59, s58, s57
    s_lshr_b32 s66, s52, 1
    s_mul_i32 s66, s66, 1
    s_mul_i32 s67, s54, 0
    s_add_u32 s66, s66, s67
    s_add_u32 s66, s66, s58
    s_mul_i32 s67, s66, 43
    s_lshr_b32 s67, s67, 7
    s_mul_i32 s67, s67, 3
    s_sub_u32 s66, s66, s67
    s_mul_i32 s60, s66, 3
    s_mul_i32 s85, s58, 43
    s_lshr_b32 s85, s85, 7
    s_lshr_b32 s66, s66, 1
    s_add_u32 s66, s66, 3
    s_cmp_lt_u32 s85, s66
    s_cselect_b32 s85, s85, 6
    s_lshl_b32 s84, s52, 2
    s_add_u32 s84, s84, s54
    s_and_b32 s65, s84, 7
    s_and_b32 s64, s84, 24
    s_add_u32 s64, s64, s55
    s_and_b32 s63, s3, 3
    s_cmp_ge_u32 s3, 4
    s_cbranch_scc1 L_aux
    s_setprio 3
    s_cmp_eq_u32 s55, 7
    s_cbranch_scc1 L_free
    s_lshl_b32 s66, s56, 7
    s_lshl_b32 s67, s63, 5
    s_add_u32 s66, s66, s67
    v_lshrrev_b32 v116, 3, v127
    v_add_u32 v116, s66, v116
    v_mul_u32_u24 v116, 1280, v116
    v_lshrrev_b32 v117, 4, v127
    v_and_b32 v118, 7, v127
    v_xor_b32 v118, v118, v117
    v_lshl_add_u32 v86, v118, 4, v116
    v_xor_b32 v87, 64, v86
    v_add_u32 v87, 9216, v87
    v_add_u32 v88, 18432, v86
    v_add_u32 v89, 18432, v87
    s_lshl_b32 s66, s63, 4
    v_add_u32 v116, s66, v117
    v_mul_u32_u24 v116, 3456, v116
    s_lshl_b32 s66, s58, 8
    v_add_u32 v116, s66, v116
    s_cmp_eq_u32 s58, 13
    s_cselect_b32 s67, 7, 15
    v_lshlrev_b32 v118, 2, v117
    v_xor_b32 v118, v118, v127
    v_and_b32 v118, s67, v118
    v_lshl_add_u32 v90, v118, 4, v116
    v_add_u32 v91, 12800, v90
    v_add_u32 v92, 25600, v90
    v_add_u32 v93, 38400, v90
    s_lshl_b32 s68, s63, 12
    s_waitcnt lgkmcnt(0)
    s_mov_b32 s36, s4
    s_mov_b32 s37, s5
    s_mov_b32 s38, 2621440
    s_mov_b32 s39, 0x20000
    s_mov_b32 s40, s20
    s_mov_b32 s41, s21
    s_mov_b32 s42, 2211840
    s_mov_b32 s43, 0x20000
    s_mul_i32 s62, s60, 221184
    s_add_u32 m0, s68, 49152
    s_lshl_b32 s61, s60, 7
    buffer_load_dwordx4 v90, s[40:43], s62 offen lds
    buffer_load_dwordx4 v91, s[40:43], s62 offen offset:1024 lds
    buffer_load_dwordx4 v92, s[40:43], s62 offen offset:2048 lds
    buffer_load_dwordx4 v93, s[40:43], s62 offen offset:3072 lds
    s_add_u32 m0, s68, 0
    s_add_u32 s60, s60, 1
    buffer_load_dwordx4 v86, s[36:39], s61 offen lds
    s_cmp_eq_u32 s60, 10
    s_cselect_b32 s60, 0, s60
    buffer_load_dwordx4 v87, s[36:39], s61 offen offset:1024 lds
    buffer_load_dwordx4 v88, s[36:39], s61 offen offset:2048 lds
    buffer_load_dwordx4 v89, s[36:39], s61 offen offset:3072 lds
    s_lshl_b32 s66, s63, 14
    s_add_u32 s66, s66, 114368
    v_lshl_add_u32 v73, v127, 2, s66
    v_lshrrev_b32 v74, 5, v127
    s_add_u32 s67, s85, 1
    v_mul_u32_u24 v74, s67, v74
    ds_write_b32 v73, v74
    v_and_b32 v72, 31, v127
    v_lshl_add_u32 v72, v72, 2, s66
    v_and_b32 v73, 3, v127
    v_lshlrev_b32 v73, 14, v73
    v_lshl_add_u32 v73, v127, 2, v73
    v_add_u32 v73, 114368, v73
    s_waitcnt lgkmcnt(0)
    s_barrier
    s_mul_i32 s62, s60, 221184
    s_add_u32 m0, s68, 65536
    s_lshl_b32 s61, s60, 7
    buffer_load_dwordx4 v90, s[40:43], s62 offen lds
    buffer_load_dwordx4 v91, s[40:43], s62 offen offset:1024 lds
    buffer_load_dwordx4 v92, s[40:43], s62 offen offset:2048 lds
    buffer_load_dwordx4 v93, s[40:43], s62 offen offset:3072 lds
    s_add_u32 m0, s68, 16384
    s_add_u32 s60, s60, 1
    buffer_load_dwordx4 v86, s[36:39], s61 offen lds
    s_cmp_eq_u32 s60, 10
    s_cselect_b32 s60, 0, s60
    buffer_load_dwordx4 v87, s[36:39], s61 offen offset:1024 lds
    buffer_load_dwordx4 v88, s[36:39], s61 offen offset:2048 lds
    buffer_load_dwordx4 v89, s[36:39], s61 offen offset:3072 lds
    s_mov_b32 s44, s34
    s_mov_b32 s45, s35
    s_mov_b32 s46, 16777216
    s_mov_b32 s47, 0x20000
    s_mov_b32 s48, s22
    s_mov_b32 s49, s23
    s_mov_b32 s50, 3456
    s_mov_b32 s51, 0x20000
    s_and_b32 s66, s63, 1
    s_lshr_b32 s67, s63, 1
    v_and_b32 v116, 31, v127
    v_bfe_u32 v118, v127, 1, 3
    v_lshrrev_b32 v119, 5, v127
    v_xor_b32 v118, v118, v119
    v_lshlrev_b32 v118, 4, v118
    v_lshl_add_u32 v118, v116, 7, v118
    s_lshl_b32 s69, s66, 13
    v_add_u32 v80, s69, v118
    v_xor_b32 v81, 32, v80
    v_xor_b32 v82, 64, v80
    v_xor_b32 v83, 96, v80
    s_lshl_b32 s69, s67, 1
    s_add_u32 s69, s69, s66
    s_lshl_b32 s70, s58, 2
    s_add_u32 s70, s70, s69
    s_lshl_b32 s70, s70, 6
    v_lshl_add_u32 v101, v116, 1, s70
    v_bfe_u32 v116, v127, 2, 2
    v_xor_b32 v118, s69, v116
    v_lshl_add_u32 v116, v119, 3, v116
    v_lshlrev_b32 v116, 8, v116
    v_lshl_add_u32 v116, v118, 6, v116
    v_and_b32 v118, 1, v117
    v_lshl_add_u32 v116, v118, 5, v116
    v_and_b32 v119, 3, v127
    v_lshl_add_u32 v116, v119, 3, v116
    v_add_u32 v84, 49152, v116
    v_xor_b32 v85, 64, v84
    v_bfe_u32 v116, v127, 3, 1
    v_cmp_eq_u32 vcc, v116, v118
    v_mov_b32 v119, 0
    v_mov_b32 v116, 0x3f803f80
    v_cndmask_b32 v96, v119, v116, vcc
    v_cndmask_b32 v97, v119, v116, vcc
    v_cndmask_b32 v98, v119, v116, vcc
    v_cndmask_b32 v99, v119, v116, vcc
    buffer_load_ushort v100, v101, s[48:51], 0 offen
    v_mov_b32 v74, 1
    s_waitcnt vmcnt(9)
    s_waitcnt lgkmcnt(0)
    ds_write_b32 v72, v74
    ds_read_b32 v75, v73
    v_mov_b32 v74, 2
    s_waitcnt lgkmcnt(0)
    v_cmp_gt_u32 vcc, 1, v75
    s_cbranch_vccnz L_slow_1
L_go_2:
    ds_read_b128 a[8:11], v80 offset:0
    ds_read_b64_tr_b16 a[0:1], v84 offset:0
    ds_read_b64_tr_b16 a[2:3], v84 offset:1024
    ds_read_b128 a[12:15], v80 offset:4096
    ds_read_b64_tr_b16 a[4:5], v85 offset:0
    ds_read_b64_tr_b16 a[6:7], v85 offset:1024
    ds_read_b128 a[24:27], v81 offset:0
    ds_read_b64_tr_b16 a[16:17], v84 offset:4096
    s_mul_i32 s62, s60, 221184
    s_add_u32 m0, s68, 81920
    s_lshl_b32 s61, s60, 7
    buffer_load_dwordx4 v90, s[40:43], s62 offen lds
    ds_read_b64_tr_b16 a[18:19], v84 offset:5120
    ds_read_b128 a[28:31], v81 offset:4096
    ds_read_b64_tr_b16 a[20:21], v85 offset:4096
    ds_read_b64_tr_b16 a[22:23], v85 offset:5120
    buffer_load_dwordx4 v91, s[40:43], s62 offen offset:1024 lds
    s_waitcnt lgkmcnt(6)
    v_mfma_f32_32x32x16_bf16 v[0:15], a[0:3], a[8:11], 0
    ds_read_b128 a[40:43], v82 offset:0
    ds_read_b64_tr_b16 a[32:33], v84 offset:8192
    v_mfma_f32_32x32x16_bf16 v[16:31], a[0:3], a[12:15], 0
    ds_read_b64_tr_b16 a[34:35], v84 offset:9216
    ds_read_b128 a[44:47], v82 offset:4096
    buffer_load_dwordx4 v92, s[40:43], s62 offen offset:2048 lds
    v_mfma_f32_32x32x16_bf16 v[32:47], a[4:7], a[8:11], 0
    ds_read_b64_tr_b16 a[36:37], v85 offset:8192
    ds_read_b64_tr_b16 a[38:39], v85 offset:9216
    v_mfma_f32_32x32x16_bf16 v[48:63], a[4:7], a[12:15], 0
    v_mfma_f32_16x16x32_bf16 v[64:67], a[0:3], v[96:99], 0
    ds_read_b128 a[56:59], v83 offset:0
    ds_read_b64_tr_b16 a[48:49], v84 offset:12288
    buffer_load_dwordx4 v93, s[40:43], s62 offen offset:3072 lds
    s_waitcnt lgkmcnt(8)
    v_mfma_f32_32x32x16_bf16 v[0:15], a[16:19], a[24:27], v[0:15]
    ds_read_b64_tr_b16 a[50:51], v84 offset:13312
    ds_read_b128 a[60:63], v83 offset:4096
    v_mfma_f32_32x32x16_bf16 v[16:31], a[16:19], a[28:31], v[16:31]
    ds_read_b64_tr_b16 a[52:53], v85 offset:12288
    ds_read_b64_tr_b16 a[54:55], v85 offset:13312
    s_add_u32 m0, s68, 32768
    s_add_u32 s60, s60, 1
    buffer_load_dwordx4 v86, s[36:39], s61 offen lds
    s_cmp_eq_u32 s60, 10
    s_cselect_b32 s60, 0, s60
    v_mfma_f32_32x32x16_bf16 v[32:47], a[20:23], a[24:27], v[32:47]
    v_mfma_f32_32x32x16_bf16 v[48:63], a[20:23], a[28:31], v[48:63]
    v_mfma_f32_16x16x32_bf16 v[64:67], a[16:19], v[96:99], v[64:67]
    buffer_load_dwordx4 v87, s[36:39], s61 offen offset:1024 lds
    s_waitcnt vmcnt(7)
    s_waitcnt lgkmcnt(0)
    ds_write_b32 v72, v74
    v_mfma_f32_32x32x16_bf16 v[0:15], a[32:35], a[40:43], v[0:15]
    v_mfma_f32_32x32x16_bf16 v[16:31], a[32:35], a[44:47], v[16:31]
    buffer_load_dwordx4 v88, s[36:39], s61 offen offset:2048 lds
    v_mfma_f32_32x32x16_bf16 v[32:47], a[36:39], a[40:43], v[32:47]
    ds_read_b32 v75, v73
    v_mov_b32 v74, 3
    v_mfma_f32_32x32x16_bf16 v[48:63], a[36:39], a[44:47], v[48:63]
    v_mfma_f32_16x16x32_bf16 v[64:67], a[32:35], v[96:99], v[64:67]
    buffer_load_dwordx4 v89, s[36:39], s61 offen offset:3072 lds
    v_mfma_f32_32x32x16_bf16 v[0:15], a[48:51], a[56:59], v[0:15]
    s_waitcnt lgkmcnt(0)
    v_cmp_gt_u32 vcc, 2, v75
    s_cbranch_vccnz L_slow_4
L_go_5:
    ds_read_b128 a[8:11], v80 offset:16384
    ds_read_b64_tr_b16 a[0:1], v84 offset:16384
    ds_read_b64_tr_b16 a[2:3], v84 offset:17408
    ds_read_b128 a[12:15], v80 offset:20480
    ds_read_b64_tr_b16 a[4:5], v85 offset:16384
    ds_read_b64_tr_b16 a[6:7], v85 offset:17408
    v_mfma_f32_32x32x16_bf16 v[16:31], a[48:51], a[60:63], v[16:31]
    ds_read_b128 a[24:27], v81 offset:16384
    ds_read_b64_tr_b16 a[16:17], v84 offset:20480
    s_mul_i32 s62, s60, 221184
    s_add_u32 m0, s68, 49152
    s_lshl_b32 s61, s60, 7
    buffer_load_dwordx4 v90, s[40:43], s62 offen lds
    v_mfma_f32_32x32x16_bf16 v[32:47], a[52:55], a[56:59], v[32:47]
    ds_read_b64_tr_b16 a[18:19], v84 offset:21504
    ds_read_b128 a[28:31], v81 offset:20480
    v_mfma_f32_32x32x16_bf16 v[48:63], a[52:55], a[60:63], v[48:63]
    v_mfma_f32_16x16x32_bf16 v[64:67], a[48:51], v[96:99], v[64:67]
    ds_read_b64_tr_b16 a[20:21], v85 offset:20480
    ds_read_b64_tr_b16 a[22:23], v85 offset:21504
    buffer_load_dwordx4 v91, s[40:43], s62 offen offset:1024 lds
    s_waitcnt lgkmcnt(6)
    v_mfma_f32_32x32x16_bf16 v[0:15], a[0:3], a[8:11], v[0:15]
    ds_read_b128 a[40:43], v82 offset:16384
    ds_read_b64_tr_b16 a[32:33], v84 offset:24576
    v_mfma_f32_32x32x16_bf16 v[16:31], a[0:3], a[12:15], v[16:31]
    ds_read_b64_tr_b16 a[34:35], v84 offset:25600
    ds_read_b128 a[44:47], v82 offset:20480
    buffer_load_dwordx4 v92, s[40:43], s62 offen offset:2048 lds
    v_mfma_f32_32x32x16_bf16 v[32:47], a[4:7], a[8:11], v[32:47]
    ds_read_b64_tr_b16 a[36:37], v85 offset:24576
    ds_read_b64_tr_b16 a[38:39], v85 offset:25600
    v_mfma_f32_32x32x16_bf16 v[48:63], a[4:7], a[12:15], v[48:63]
    v_mfma_f32_16x16x32_bf16 v[64:67], a[0:3], v[96:99], v[64:67]
    ds_read_b128 a[56:59], v83 offset:16384
    ds_read_b64_tr_b16 a[48:49], v84 offset:28672
    buffer_load_dwordx4 v93, s[40:43], s62 offen offset:3072 lds
    s_waitcnt lgkmcnt(8)
    v_mfma_f32_32x32x16_bf16 v[0:15], a[16:19], a[24:27], v[0:15]
    ds_read_b64_tr_b16 a[50:51], v84 offset:29696
    ds_read_b128 a[60:63], v83 offset:20480
    v_mfma_f32_32x32x16_bf16 v[16:31], a[16:19], a[28:31], v[16:31]
    ds_read_b64_tr_b16 a[52:53], v85 offset:28672
    ds_read_b64_tr_b16 a[54:55], v85 offset:29696
    s_add_u32 m0, s68, 0
    s_add_u32 s60, s60, 1
    buffer_load_dwordx4 v86, s[36:39], s61 offen lds
    s_cmp_eq_u32 s60, 10
    s_cselect_b32 s60, 0, s60
    v_mfma_f32_32x32x16_bf16 v[32:47], a[20:23], a[24:27], v[32:47]
    v_mfma_f32_32x32x16_bf16 v[48:63], a[20:23], a[28:31], v[48:63]
    v_mfma_f32_16x16x32_bf16 v[64:67], a[16:19], v[96:99], v[64:67]
    buffer_load_dwordx4 v87, s[36:39], s61 offen offset:1024 lds
    s_waitcnt vmcnt(6)
    s_waitcnt lgkmcnt(0)
    ds_write_b32 v72, v74
    v_mfma_f32_32x32x16_bf16 v[0:15], a[32:35], a[40:43], v[0:15]
    v_mfma_f32_32x32x16_bf16 v[16:31], a[32:35], a[44:47], v[16:31]
    buffer_load_dwordx4 v88, s[36:39], s61 offen offset:2048 lds
    v_mfma_f32_32x32x16_bf16 v[32:47], a[36:39], a[40:43], v[32:47]
    ds_read_b32 v75, v73
    v_mov_b32 v74, 4
    v_mfma_f32_32x32x16_bf16 v[48:63], a[36:39], a[44:47], v[48:63]
    v_mfma_f32_16x16x32_bf16 v[64:67], a[32:35], v[96:99], v[64:67]
    buffer_load_dwordx4 v89, s[36:39], s61 offen offset:3072 lds
    v_mfma_f32_32x32x16_bf16 v[0:15], a[48:51], a[56:59], v[0:15]
    s_waitcnt lgkmcnt(0)
    v_cmp_gt_u32 vcc, 3, v75
    s_cbranch_vccnz L_slow_7
L_go_8:
    ds_read_b128 a[8:11], v80 offset:32768
    ds_read_b64_tr_b16 a[0:1], v84 offset:32768
    ds_read_b64_tr_b16 a[2:3], v84 offset:33792
    ds_read_b128 a[12:15], v80 offset:36864
    ds_read_b64_tr_b16 a[4:5], v85 offset:32768
    ds_read_b64_tr_b16 a[6:7], v85 offset:33792
    v_mfma_f32_32x32x16_bf16 v[16:31], a[48:51], a[60:63], v[16:31]
    ds_read_b128 a[24:27], v81 offset:32768
    ds_read_b64_tr_b16 a[16:17], v84 offset:36864
    s_mul_i32 s62, s60, 221184
    s_add_u32 m0, s68, 65536
    s_lshl_b32 s61, s60, 7
    buffer_load_dwordx4 v90, s[40:43], s62 offen lds
    v_mfma_f32_32x32x16_bf16 v[32:47], a[52:55], a[56:59], v[32:47]
    ds_read_b64_tr_b16 a[18:19], v84 offset:37888
    ds_read_b128 a[28:31], v81 offset:36864
    v_mfma_f32_32x32x16_bf16 v[48:63], a[52:55], a[60:63], v[48:63]
    v_mfma_f32_16x16x32_bf16 v[64:67], a[48:51], v[96:99], v[64:67]
    ds_read_b64_tr_b16 a[20:21], v85 offset:36864
    ds_read_b64_tr_b16 a[22:23], v85 offset:37888
    buffer_load_dwordx4 v91, s[40:43], s62 offen offset:1024 lds
    s_waitcnt lgkmcnt(6)
    v_mfma_f32_32x32x16_bf16 v[0:15], a[0:3], a[8:11], v[0:15]
    ds_read_b128 a[40:43], v82 offset:32768
    ds_read_b64_tr_b16 a[32:33], v84 offset:40960
    v_mfma_f32_32x32x16_bf16 v[16:31], a[0:3], a[12:15], v[16:31]
    ds_read_b64_tr_b16 a[34:35], v84 offset:41984
    ds_read_b128 a[44:47], v82 offset:36864
    buffer_load_dwordx4 v92, s[40:43], s62 offen offset:2048 lds
    v_mfma_f32_32x32x16_bf16 v[32:47], a[4:7], a[8:11], v[32:47]
    ds_read_b64_tr_b16 a[36:37], v85 offset:40960
    ds_read_b64_tr_b16 a[38:39], v85 offset:41984
    v_mfma_f32_32x32x16_bf16 v[48:63], a[4:7], a[12:15], v[48:63]
    v_mfma_f32_16x16x32_bf16 v[64:67], a[0:3], v[96:99], v[64:67]
    ds_read_b128 a[56:59], v83 offset:32768
    ds_read_b64_tr_b16 a[48:49], v84 offset:45056
    buffer_load_dwordx4 v93, s[40:43], s62 offen offset:3072 lds
    s_waitcnt lgkmcnt(8)
    v_mfma_f32_32x32x16_bf16 v[0:15], a[16:19], a[24:27], v[0:15]
    ds_read_b64_tr_b16 a[50:51], v84 offset:46080
    ds_read_b128 a[60:63], v83 offset:36864
    v_mfma_f32_32x32x16_bf16 v[16:31], a[16:19], a[28:31], v[16:31]
    ds_read_b64_tr_b16 a[52:53], v85 offset:45056
    ds_read_b64_tr_b16 a[54:55], v85 offset:46080
    s_add_u32 m0, s68, 16384
    s_add_u32 s60, s60, 1
    buffer_load_dwordx4 v86, s[36:39], s61 offen lds
    s_cmp_eq_u32 s60, 10
    s_cselect_b32 s60, 0, s60
    v_mfma_f32_32x32x16_bf16 v[32:47], a[20:23], a[24:27], v[32:47]
    v_mfma_f32_32x32x16_bf16 v[48:63], a[20:23], a[28:31], v[48:63]
    v_mfma_f32_16x16x32_bf16 v[64:67], a[16:19], v[96:99], v[64:67]
    buffer_load_dwordx4 v87, s[36:39], s61 offen offset:1024 lds
    s_waitcnt vmcnt(6)
    s_waitcnt lgkmcnt(0)
    ds_write_b32 v72, v74
    v_mfma_f32_32x32x16_bf16 v[0:15], a[32:35], a[40:43], v[0:15]
    v_mfma_f32_32x32x16_bf16 v[16:31], a[32:35], a[44:47], v[16:31]
    buffer_load_dwordx4 v88, s[36:39], s61 offen offset:2048 lds
    v_mfma_f32_32x32x16_bf16 v[32:47], a[36:39], a[40:43], v[32:47]
    ds_read_b32 v75, v73
    v_mov_b32 v74, 5
    v_mfma_f32_32x32x16_bf16 v[48:63], a[36:39], a[44:47], v[48:63]
    v_mfma_f32_16x16x32_bf16 v[64:67], a[32:35], v[96:99], v[64:67]
    buffer_load_dwordx4 v89, s[36:39], s61 offen offset:3072 lds
    v_mfma_f32_32x32x16_bf16 v[0:15], a[48:51], a[56:59], v[0:15]
    s_waitcnt lgkmcnt(0)
    v_cmp_gt_u32 vcc, 4, v75
    s_cbranch_vccnz L_slow_10
L_go_11:
    ds_read_b128 a[8:11], v80 offset:0
    ds_read_b64_tr_b16 a[0:1], v84 offset:0
    ds_read_b64_tr_b16 a[2:3], v84 offset:1024
    ds_read_b128 a[12:15], v80 offset:4096
    ds_read_b64_tr_b16 a[4:5], v85 offset:0
    ds_read_b64_tr_b16 a[6:7], v85 offset:1024
    v_mfma_f32_32x32x16_bf16 v[16:31], a[48:51], a[60:63], v[16:31]
    ds_read_b128 a[24:27], v81 offset:0
    ds_read_b64_tr_b16 a[16:17], v84 offset:4096
    s_mul_i32 s62, s60, 221184
    s_add_u32 m0, s68, 81920
    s_lshl_b32 s61, s60, 7
    buffer_load_dwordx4 v90, s[40:43], s62 offen lds
    v_mfma_f32_32x32x16_bf16 v[32:47], a[52:55], a[56:59], v[32:47]
    ds_read_b64_tr_b16 a[18:19], v84 offset:5120
    ds_read_b128 a[28:31], v81 offset:4096
    v_mfma_f32_32x32x16_bf16 v[48:63], a[52:55], a[60:63], v[48:63]
    v_mfma_f32_16x16x32_bf16 v[64:67], a[48:51], v[96:99], v[64:67]
    ds_read_b64_tr_b16 a[20:21], v85 offset:4096
    ds_read_b64_tr_b16 a[22:23], v85 offset:5120
    buffer_load_dwordx4 v91, s[40:43], s62 offen offset:1024 lds
    s_waitcnt lgkmcnt(6)
    v_mfma_f32_32x32x16_bf16 v[0:15], a[0:3], a[8:11], v[0:15]
    ds_read_b128 a[40:43], v82 offset:0
    ds_read_b64_tr_b16 a[32:33], v84 offset:8192
    v_mfma_f32_32x32x16_bf16 v[16:31], a[0:3], a[12:15], v[16:31]
    ds_read_b64_tr_b16 a[34:35], v84 offset:9216
    ds_read_b128 a[44:47], v82 offset:4096
    buffer_load_dwordx4 v92, s[40:43], s62 offen offset:2048 lds
    v_mfma_f32_32x32x16_bf16 v[32:47], a[4:7], a[8:11], v[32:47]
    ds_read_b64_tr_b16 a[36:37], v85 offset:8192
    ds_read_b64_tr_b16 a[38:39], v85 offset:9216
    v_mfma_f32_32x32x16_bf16 v[48:63], a[4:7], a[12:15], v[48:63]
    v_mfma_f32_16x16x32_bf16 v[64:67], a[0:3], v[96:99], v[64:67]
    ds_read_b128 a[56:59], v83 offset:0
    ds_read_b64_tr_b16 a[48:49], v84 offset:12288
    buffer_load_dwordx4 v93, s[40:43], s62 offen offset:3072 lds
    s_waitcnt lgkmcnt(8)
    v_mfma_f32_32x32x16_bf16 v[0:15], a[16:19], a[24:27], v[0:15]
    ds_read_b64_tr_b16 a[50:51], v84 offset:13312
    ds_read_b128 a[60:63], v83 offset:4096
    v_mfma_f32_32x32x16_bf16 v[16:31], a[16:19], a[28:31], v[16:31]
    ds_read_b64_tr_b16 a[52:53], v85 offset:12288
    ds_read_b64_tr_b16 a[54:55], v85 offset:13312
    s_add_u32 m0, s68, 32768
    s_add_u32 s60, s60, 1
    buffer_load_dwordx4 v86, s[36:39], s61 offen lds
    s_cmp_eq_u32 s60, 10
    s_cselect_b32 s60, 0, s60
    v_mfma_f32_32x32x16_bf16 v[32:47], a[20:23], a[24:27], v[32:47]
    v_mfma_f32_32x32x16_bf16 v[48:63], a[20:23], a[28:31], v[48:63]
    v_mfma_f32_16x16x32_bf16 v[64:67], a[16:19], v[96:99], v[64:67]
    buffer_load_dwordx4 v87, s[36:39], s61 offen offset:1024 lds
    s_waitcnt vmcnt(6)
    s_waitcnt lgkmcnt(0)
    ds_write_b32 v72, v74
    v_mfma_f32_32x32x16_bf16 v[0:15], a[32:35], a[40:43], v[0:15]
    v_mfma_f32_32x32x16_bf16 v[16:31], a[32:35], a[44:47], v[16:31]
    buffer_load_dwordx4 v88, s[36:39], s61 offen offset:2048 lds
    v_mfma_f32_32x32x16_bf16 v[32:47], a[36:39], a[40:43], v[32:47]
    ds_read_b32 v75, v73
    v_mov_b32 v74, 6
    v_mfma_f32_32x32x16_bf16 v[48:63], a[36:39], a[44:47], v[48:63]
    v_mfma_f32_16x16x32_bf16 v[64:67], a[32:35], v[96:99], v[64:67]
    buffer_load_dwordx4 v89, s[36:39], s61 offen offset:3072 lds
    v_mfma_f32_32x32x16_bf16 v[0:15], a[48:51], a[56:59], v[0:15]
    s_waitcnt lgkmcnt(0)
    v_cmp_gt_u32 vcc, 5, v75
    s_cbranch_vccnz L_slow_13
L_go_14:
    ds_read_b128 a[8:11], v80 offset:16384
    ds_read_b64_tr_b16 a[0:1], v84 offset:16384
    ds_read_b64_tr_b16 a[2:3], v84 offset:17408
    ds_read_b128 a[12:15], v80 offset:20480
    ds_read_b64_tr_b16 a[4:5], v85 offset:16384
    ds_read_b64_tr_b16 a[6:7], v85 offset:17408
    v_mfma_f32_32x32x16_bf16 v[16:31], a[48:51], a[60:63], v[16:31]
    ds_read_b128 a[24:27], v81 offset:16384
    ds_read_b64_tr_b16 a[16:17], v84 offset:20480
    s_mul_i32 s62, s60, 221184
    s_add_u32 m0, s68, 49152
    s_lshl_b32 s61, s60, 7
    buffer_load_dwordx4 v90, s[40:43], s62 offen lds
    v_mfma_f32_32x32x16_bf16 v[32:47], a[52:55], a[56:59], v[32:47]
    ds_read_b64_tr_b16 a[18:19], v84 offset:21504
    ds_read_b128 a[28:31], v81 offset:20480
    v_mfma_f32_32x32x16_bf16 v[48:63], a[52:55], a[60:63], v[48:63]
    v_mfma_f32_16x16x32_bf16 v[64:67], a[48:51], v[96:99], v[64:67]
    ds_read_b64_tr_b16 a[20:21], v85 offset:20480
    ds_read_b64_tr_b16 a[22:23], v85 offset:21504
    buffer_load_dwordx4 v91, s[40:43], s62 offen offset:1024 lds
    s_waitcnt lgkmcnt(6)
    v_mfma_f32_32x32x16_bf16 v[0:15], a[0:3], a[8:11], v[0:15]
    ds_read_b128 a[40:43], v82 offset:16384
    ds_read_b64_tr_b16 a[32:33], v84 offset:24576
    v_mfma_f32_32x32x16_bf16 v[16:31], a[0:3], a[12:15], v[16:31]
    ds_read_b64_tr_b16 a[34:35], v84 offset:25600
    ds_read_b128 a[44:47], v82 offset:20480
    buffer_load_dwordx4 v92, s[40:43], s62 offen offset:2048 lds
    v_mfma_f32_32x32x16_bf16 v[32:47], a[4:7], a[8:11], v[32:47]
    ds_read_b64_tr_b16 a[36:37], v85 offset:24576
    ds_read_b64_tr_b16 a[38:39], v85 offset:25600
    v_mfma_f32_32x32x16_bf16 v[48:63], a[4:7], a[12:15], v[48:63]
    v_mfma_f32_16x16x32_bf16 v[64:67], a[0:3], v[96:99], v[64:67]
    ds_read_b128 a[56:59], v83 offset:16384
    ds_read_b64_tr_b16 a[48:49], v84 offset:28672
    buffer_load_dwordx4 v93, s[40:43], s62 offen offset:3072 lds
    s_waitcnt lgkmcnt(8)
    v_mfma_f32_32x32x16_bf16 v[0:15], a[16:19], a[24:27], v[0:15]
    ds_read_b64_tr_b16 a[50:51], v84 offset:29696
    ds_read_b128 a[60:63], v83 offset:20480
    v_mfma_f32_32x32x16_bf16 v[16:31], a[16:19], a[28:31], v[16:31]
    ds_read_b64_tr_b16 a[52:53], v85 offset:28672
    ds_read_b64_tr_b16 a[54:55], v85 offset:29696
    s_add_u32 m0, s68, 0
    s_add_u32 s60, s60, 1
    buffer_load_dwordx4 v86, s[36:39], s61 offen lds
    s_cmp_eq_u32 s60, 10
    s_cselect_b32 s60, 0, s60
    v_mfma_f32_32x32x16_bf16 v[32:47], a[20:23], a[24:27], v[32:47]
    v_mfma_f32_32x32x16_bf16 v[48:63], a[20:23], a[28:31], v[48:63]
    v_mfma_f32_16x16x32_bf16 v[64:67], a[16:19], v[96:99], v[64:67]
    buffer_load_dwordx4 v87, s[36:39], s61 offen offset:1024 lds
    s_waitcnt vmcnt(6)
    s_waitcnt lgkmcnt(0)
    ds_write_b32 v72, v74
    v_mfma_f32_32x32x16_bf16 v[0:15], a[32:35], a[40:43], v[0:15]
    v_mfma_f32_32x32x16_bf16 v[16:31], a[32:35], a[44:47], v[16:31]
    buffer_load_dwordx4 v88, s[36:39], s61 offen offset:2048 lds
    v_mfma_f32_32x32x16_bf16 v[32:47], a[36:39], a[40:43], v[32:47]
    ds_read_b32 v75, v73
    v_mov_b32 v74, 7
    v_mfma_f32_32x32x16_bf16 v[48:63], a[36:39], a[44:47], v[48:63]
    v_mfma_f32_16x16x32_bf16 v[64:67], a[32:35], v[96:99], v[64:67]
    buffer_load_dwordx4 v89, s[36:39], s61 offen offset:3072 lds
    v_mfma_f32_32x32x16_bf16 v[0:15], a[48:51], a[56:59], v[0:15]
    s_waitcnt lgkmcnt(0)
    v_cmp_gt_u32 vcc, 6, v75
    s_cbranch_vccnz L_slow_16
L_go_17:
    ds_read_b128 a[8:11], v80 offset:32768
    ds_read_b64_tr_b16 a[0:1], v84 offset:32768
    ds_read_b64_tr_b16 a[2:3], v84 offset:33792
    ds_read_b128 a[12:15], v80 offset:36864
    ds_read_b64_tr_b16 a[4:5], v85 offset:32768
    ds_read_b64_tr_b16 a[6:7], v85 offset:33792
    v_mfma_f32_32x32x16_bf16 v[16:31], a[48:51], a[60:63], v[16:31]
    ds_read_b128 a[24:27], v81 offset:32768
    ds_read_b64_tr_b16 a[16:17], v84 offset:36864
    s_mul_i32 s62, s60, 221184
    s_add_u32 m0, s68, 65536
    s_lshl_b32 s61, s60, 7
    buffer_load_dwordx4 v90, s[40:43], s62 offen lds
    v_mfma_f32_32x32x16_bf16 v[32:47], a[52:55], a[56:59], v[32:47]
    ds_read_b64_tr_b16 a[18:19], v84 offset:37888
    ds_read_b128 a[28:31], v81 offset:36864
    v_mfma_f32_32x32x16_bf16 v[48:63], a[52:55], a[60:63], v[48:63]
    v_mfma_f32_16x16x32_bf16 v[64:67], a[48:51], v[96:99], v[64:67]
    ds_read_b64_tr_b16 a[20:21], v85 offset:36864
    ds_read_b64_tr_b16 a[22:23], v85 offset:37888
    buffer_load_dwordx4 v91, s[40:43], s62 offen offset:1024 lds
    s_waitcnt lgkmcnt(6)
    v_mfma_f32_32x32x16_bf16 v[0:15], a[0:3], a[8:11], v[0:15]
    ds_read_b128 a[40:43], v82 offset:32768
    ds_read_b64_tr_b16 a[32:33], v84 offset:40960
    v_mfma_f32_32x32x16_bf16 v[16:31], a[0:3], a[12:15], v[16:31]
    ds_read_b64_tr_b16 a[34:35], v84 offset:41984
    ds_read_b128 a[44:47], v82 offset:36864
    buffer_load_dwordx4 v92, s[40:43], s62 offen offset:2048 lds
    v_mfma_f32_32x32x16_bf16 v[32:47], a[4:7], a[8:11], v[32:47]
    ds_read_b64_tr_b16 a[36:37], v85 offset:40960
    ds_read_b64_tr_b16 a[38:39], v85 offset:41984
    v_mfma_f32_32x32x16_bf16 v[48:63], a[4:7], a[12:15], v[48:63]
    v_mfma_f32_16x16x32_bf16 v[64:67], a[0:3], v[96:99], v[64:67]
    ds_read_b128 a[56:59], v83 offset:32768
    ds_read_b64_tr_b16 a[48:49], v84 offset:45056
    buffer_load_dwordx4 v93, s[40:43], s62 offen offset:3072 lds
    s_waitcnt lgkmcnt(8)
    v_mfma_f32_32x32x16_bf16 v[0:15], a[16:19], a[24:27], v[0:15]
    ds_read_b64_tr_b16 a[50:51], v84 offset:46080
    ds_read_b128 a[60:63], v83 offset:36864
    v_mfma_f32_32x32x16_bf16 v[16:31], a[16:19], a[28:31], v[16:31]
    ds_read_b64_tr_b16 a[52:53], v85 offset:45056
    ds_read_b64_tr_b16 a[54:55], v85 offset:46080
    s_add_u32 m0, s68, 16384
    s_add_u32 s60, s60, 1
    buffer_load_dwordx4 v86, s[36:39], s61 offen lds
    s_cmp_eq_u32 s60, 10
    s_cselect_b32 s60, 0, s60
    v_mfma_f32_32x32x16_bf16 v[32:47], a[20:23], a[24:27], v[32:47]
    v_mfma_f32_32x32x16_bf16 v[48:63], a[20:23], a[28:31], v[48:63]
    v_mfma_f32_16x16x32_bf16 v[64:67], a[16:19], v[96:99], v[64:67]
    buffer_load_dwordx4 v87, s[36:39], s61 offen offset:1024 lds
    s_waitcnt vmcnt(6)
    s_waitcnt lgkmcnt(0)
    ds_write_b32 v72, v74
    v_mfma_f32_32x32x16_bf16 v[0:15], a[32:35], a[40:43], v[0:15]
    v_mfma_f32_32x32x16_bf16 v[16:31], a[32:35], a[44:47], v[16:31]
    buffer_load_dwordx4 v88, s[36:39], s61 offen offset:2048 lds
    v_mfma_f32_32x32x16_bf16 v[32:47], a[36:39], a[40:43], v[32:47]
    ds_read_b32 v75, v73
    v_mov_b32 v74, 8
    v_mfma_f32_32x32x16_bf16 v[48:63], a[36:39], a[44:47], v[48:63]
    v_mfma_f32_16x16x32_bf16 v[64:67], a[32:35], v[96:99], v[64:67]
    buffer_load_dwordx4 v89, s[36:39], s61 offen offset:3072 lds
    v_mfma_f32_32x32x16_bf16 v[0:15], a[48:51], a[56:59], v[0:15]
    s_waitcnt lgkmcnt(0)
    v_cmp_gt_u32 vcc, 7, v75
    s_cbranch_vccnz L_slow_19
L_go_20:
    ds_read_b128 a[8:11], v80 offset:0
    ds_read_b64_tr_b16 a[0:1], v84 offset:0
    ds_read_b64_tr_b16 a[2:3], v84 offset:1024
    ds_read_b128 a[12:15], v80 offset:4096
    ds_read_b64_tr_b16 a[4:5], v85 offset:0
    ds_read_b64_tr_b16 a[6:7], v85 offset:1024
    v_mfma_f32_32x32x16_bf16 v[16:31], a[48:51], a[60:63], v[16:31]
    ds_read_b128 a[24:27], v81 offset:0
    ds_read_b64_tr_b16 a[16:17], v84 offset:4096
    s_mul_i32 s62, s60, 221184
    s_add_u32 m0, s68, 81920
    s_lshl_b32 s61, s60, 7
    buffer_load_dwordx4 v90, s[40:43], s62 offen lds
    v_mfma_f32_32x32x16_bf16 v[32:47], a[52:55], a[56:59], v[32:47]
    ds_read_b64_tr_b16 a[18:19], v84 offset:5120
    ds_read_b128 a[28:31], v81 offset:4096
    v_mfma_f32_32x32x16_bf16 v[48:63], a[52:55], a[60:63], v[48:63]
    v_mfma_f32_16x16x32_bf16 v[64:67], a[48:51], v[96:99], v[64:67]
    ds_read_b64_tr_b16 a[20:21], v85 offset:4096
    ds_read_b64_tr_b16 a[22:23], v85 offset:5120
    buffer_load_dwordx4 v91, s[40:43], s62 offen offset:1024 lds
    s_waitcnt lgkmcnt(6)
    v_mfma_f32_32x32x16_bf16 v[0:15], a[0:3], a[8:11], v[0:15]
    ds_read_b128 a[40:43], v82 offset:0
    ds_read_b64_tr_b16 a[32:33], v84 offset:8192
    v_mfma_f32_32x32x16_bf16 v[16:31], a[0:3], a[12:15], v[16:31]
    ds_read_b64_tr_b16 a[34:35], v84 offset:9216
    ds_read_b128 a[44:47], v82 offset:4096
    buffer_load_dwordx4 v92, s[40:43], s62 offen offset:2048 lds
    v_mfma_f32_32x32x16_bf16 v[32:47], a[4:7], a[8:11], v[32:47]
    ds_read_b64_tr_b16 a[36:37], v85 offset:8192
    ds_read_b64_tr_b16 a[38:39], v85 offset:9216
    v_mfma_f32_32x32x16_bf16 v[48:63], a[4:7], a[12:15], v[48:63]
    v_mfma_f32_16x16x32_bf16 v[64:67], a[0:3], v[96:99], v[64:67]
    ds_read_b128 a[56:59], v83 offset:0
    ds_read_b64_tr_b16 a[48:49], v84 offset:12288
    buffer_load_dwordx4 v93, s[40:43], s62 offen offset:3072 lds
    s_waitcnt lgkmcnt(8)
    v_mfma_f32_32x32x16_bf16 v[0:15], a[16:19], a[24:27], v[0:15]
    ds_read_b64_tr_b16 a[50:51], v84 offset:13312
    ds_read_b128 a[60:63], v83 offset:4096
    v_mfma_f32_32x32x16_bf16 v[16:31], a[16:19], a[28:31], v[16:31]
    ds_read_b64_tr_b16 a[52:53], v85 offset:12288
    ds_read_b64_tr_b16 a[54:55], v85 offset:13312
    s_add_u32 m0, s68, 32768
    s_add_u32 s60, s60, 1
    buffer_load_dwordx4 v86, s[36:39], s61 offen lds
    s_cmp_eq_u32 s60, 10
    s_cselect_b32 s60, 0, s60
    v_mfma_f32_32x32x16_bf16 v[32:47], a[20:23], a[24:27], v[32:47]
    v_mfma_f32_32x32x16_bf16 v[48:63], a[20:23], a[28:31], v[48:63]
    v_mfma_f32_16x16x32_bf16 v[64:67], a[16:19], v[96:99], v[64:67]
    buffer_load_dwordx4 v87, s[36:39], s61 offen offset:1024 lds
    s_waitcnt vmcnt(6)
    s_waitcnt lgkmcnt(0)
    ds_write_b32 v72, v74
    v_mfma_f32_32x32x16_bf16 v[0:15], a[32:35], a[40:43], v[0:15]
    v_mfma_f32_32x32x16_bf16 v[16:31], a[32:35], a[44:47], v[16:31]
    buffer_load_dwordx4 v88, s[36:39], s61 offen offset:2048 lds
    v_mfma_f32_32x32x16_bf16 v[32:47], a[36:39], a[40:43], v[32:47]
    ds_read_b32 v75, v73
    v_mov_b32 v74, 9
    v_mfma_f32_32x32x16_bf16 v[48:63], a[36:39], a[44:47], v[48:63]
    v_mfma_f32_16x16x32_bf16 v[64:67], a[32:35], v[96:99], v[64:67]
    buffer_load_dwordx4 v89, s[36:39], s61 offen offset:3072 lds
    v_mfma_f32_32x32x16_bf16 v[0:15], a[48:51], a[56:59], v[0:15]
    s_waitcnt lgkmcnt(0)
    v_cmp_gt_u32 vcc, 8, v75
    s_cbranch_vccnz L_slow_22
L_go_23:
    ds_read_b128 a[8:11], v80 offset:16384
    ds_read_b64_tr_b16 a[0:1], v84 offset:16384
    ds_read_b64_tr_b16 a[2:3], v84 offset:17408
    ds_read_b128 a[12:15], v80 offset:20480
    ds_read_b64_tr_b16 a[4:5], v85 offset:16384
    ds_read_b64_tr_b16 a[6:7], v85 offset:17408
    v_mfma_f32_32x32x16_bf16 v[16:31], a[48:51], a[60:63], v[16:31]
    ds_read_b128 a[24:27], v81 offset:16384
    ds_read_b64_tr_b16 a[16:17], v84 offset:20480
    s_mul_i32 s62, s60, 221184
    s_add_u32 m0, s68, 49152
    s_lshl_b32 s61, s60, 7
    buffer_load_dwordx4 v90, s[40:43], s62 offen lds
    v_mfma_f32_32x32x16_bf16 v[32:47], a[52:55], a[56:59], v[32:47]
    ds_read_b64_tr_b16 a[18:19], v84 offset:21504
    ds_read_b128 a[28:31], v81 offset:20480
    v_mfma_f32_32x32x16_bf16 v[48:63], a[52:55], a[60:63], v[48:63]
    v_mfma_f32_16x16x32_bf16 v[64:67], a[48:51], v[96:99], v[64:67]
    ds_read_b64_tr_b16 a[20:21], v85 offset:20480
    ds_read_b64_tr_b16 a[22:23], v85 offset:21504
    buffer_load_dwordx4 v91, s[40:43], s62 offen offset:1024 lds
    s_waitcnt lgkmcnt(6)
    v_mfma_f32_32x32x16_bf16 v[0:15], a[0:3], a[8:11], v[0:15]
    ds_read_b128 a[40:43], v82 offset:16384
    ds_read_b64_tr_b16 a[32:33], v84 offset:24576
    v_mfma_f32_32x32x16_bf16 v[16:31], a[0:3], a[12:15], v[16:31]
    ds_read_b64_tr_b16 a[34:35], v84 offset:25600
    ds_read_b128 a[44:47], v82 offset:20480
    buffer_load_dwordx4 v92, s[40:43], s62 offen offset:2048 lds
    v_mfma_f32_32x32x16_bf16 v[32:47], a[4:7], a[8:11], v[32:47]
    ds_read_b64_tr_b16 a[36:37], v85 offset:24576
    ds_read_b64_tr_b16 a[38:39], v85 offset:25600
    v_mfma_f32_32x32x16_bf16 v[48:63], a[4:7], a[12:15], v[48:63]
    v_mfma_f32_16x16x32_bf16 v[64:67], a[0:3], v[96:99], v[64:67]
    ds_read_b128 a[56:59], v83 offset:16384
    ds_read_b64_tr_b16 a[48:49], v84 offset:28672
    buffer_load_dwordx4 v93, s[40:43], s62 offen offset:3072 lds
    s_waitcnt lgkmcnt(8)
    v_mfma_f32_32x32x16_bf16 v[0:15], a[16:19], a[24:27], v[0:15]
    ds_read_b64_tr_b16 a[50:51], v84 offset:29696
    ds_read_b128 a[60:63], v83 offset:20480
    v_mfma_f32_32x32x16_bf16 v[16:31], a[16:19], a[28:31], v[16:31]
    ds_read_b64_tr_b16 a[52:53], v85 offset:28672
    ds_read_b64_tr_b16 a[54:55], v85 offset:29696
    s_add_u32 m0, s68, 0
    s_add_u32 s60, s60, 1
    buffer_load_dwordx4 v86, s[36:39], s61 offen lds
    s_cmp_eq_u32 s60, 10
    s_cselect_b32 s60, 0, s60
    v_mfma_f32_32x32x16_bf16 v[32:47], a[20:23], a[24:27], v[32:47]
    v_mfma_f32_32x32x16_bf16 v[48:63], a[20:23], a[28:31], v[48:63]
    v_mfma_f32_16x16x32_bf16 v[64:67], a[16:19], v[96:99], v[64:67]
    buffer_load_dwordx4 v87, s[36:39], s61 offen offset:1024 lds
    s_waitcnt vmcnt(6)
    s_waitcnt lgkmcnt(0)
    ds_write_b32 v72, v74
    v_mfma_f32_32x32x16_bf16 v[0:15], a[32:35], a[40:43], v[0:15]
    v_mfma_f32_32x32x16_bf16 v[16:31], a[32:35], a[44:47], v[16:31]
    buffer_load_dwordx4 v88, s[36:39], s61 offen offset:2048 lds
    v_mfma_f32_32x32x16_bf16 v[32:47], a[36:39], a[40:43], v[32:47]
    ds_read_b32 v75, v73
    v_mov_b32 v74, 10
    v_mfma_f32_32x32x16_bf16 v[48:63], a[36:39], a[44:47], v[48:63]
    v_mfma_f32_16x16x32_bf16 v[64:67], a[32:35], v[96:99], v[64:67]
    buffer_load_dwordx4 v89, s[36:39], s61 offen offset:3072 lds
    s_lshl_b32 s19, s56, 1
    s_add_u32 s19, s19, s66
    s_lshl_b32 s19, s19, 10
    s_add_u32 s19, s19, 16384
    v_and_b32 v102, 31, v127
    v_lshlrev_b32 v102, 4, v102
    buffer_load_dwordx2 v[108:109], v102, s[44:47], s19 offen offset:0 sc0 sc1
    buffer_load_dwordx2 v[110:111], v102, s[44:47], s19 offen offset:512 sc0 sc1
    s_lshr_b32 s12, s65, 2
    s_lshl_b32 s12, s12, 13
    s_add_u32 s12, s12, 3047424
    s_mul_i32 s13, s63, 1792
    s_min_u32 s13, s13, 5120
    s_add_u32 s12, s12, s13
    v_lshrrev_b32 v115, 1, v127
    v_min_u32 v115, 13, v115
    v_and_b32 v114, 1, v127
    v_lshl_add_u32 v114, v114, 2, s12
    v_lshl_add_u32 v115, v115, 7, v114
    buffer_load_dword v114, v115, s[44:47], 0 offen offset:0 sc0 sc1
    v_mfma_f32_32x32x16_bf16 v[0:15], a[48:51], a[56:59], v[0:15]
    s_waitcnt lgkmcnt(0)
    v_cmp_gt_u32 vcc, 9, v75
    s_cbranch_vccnz L_slow_25
L_go_26:
    ds_read_b128 a[8:11], v80 offset:32768
    ds_read_b64_tr_b16 a[0:1], v84 offset:32768
    ds_read_b64_tr_b16 a[2:3], v84 offset:33792
    ds_read_b128 a[12:15], v80 offset:36864
    ds_read_b64_tr_b16 a[4:5], v85 offset:32768
    ds_read_b64_tr_b16 a[6:7], v85 offset:33792
    v_mfma_f32_32x32x16_bf16 v[16:31], a[48:51], a[60:63], v[16:31]
    ds_read_b128 a[24:27], v81 offset:32768
    ds_read_b64_tr_b16 a[16:17], v84 offset:36864
    s_mul_i32 s12, s63, 14
    s_cmp_eq_u32 s63, 3
    s_cselect_b32 s12, 41, s12
    s_cmp_ge_u32 s63, 2
    s_cselect_b32 s13, 13, 14
    v_mfma_f32_32x32x16_bf16 v[32:47], a[52:55], a[56:59], v[32:47]
    ds_read_b64_tr_b16 a[18:19], v84 offset:37888
    ds_read_b128 a[28:31], v81 offset:36864
    s_mul_i32 s14, s55, 3
    s_lshr_b32 s14, s14, 1
    s_mul_i32 s15, s54, 3
    s_add_u32 s14, s14, s15
    v_mfma_f32_32x32x16_bf16 v[48:63], a[52:55], a[60:63], v[48:63]
    v_mfma_f32_16x16x32_bf16 v[64:67], a[48:51], v[96:99], v[64:67]
    ds_read_b64_tr_b16 a[20:21], v85 offset:36864
    ds_read_b64_tr_b16 a[22:23], v85 offset:37888
    s_cmp_ge_u32 s14, s13
    s_cselect_b32 s15, s13, 0
    s_sub_u32 s14, s14, s15
    s_add_u32 s13, s13, s12
    s_waitcnt lgkmcnt(6)
    v_mfma_f32_32x32x16_bf16 v[0:15], a[0:3], a[8:11], v[0:15]
    ds_read_b128 a[40:43], v82 offset:32768
    ds_read_b64_tr_b16 a[32:33], v84 offset:40960
    s_add_u32 s72, s12, s14
    s_add_u32 s73, s72, 1
    s_cmp_eq_u32 s73, s13
    s_cselect_b32 s73, s12, s73
    v_mfma_f32_32x32x16_bf16 v[16:31], a[0:3], a[12:15], v[16:31]
    ds_read_b64_tr_b16 a[34:35], v84 offset:41984
    ds_read_b128 a[44:47], v82 offset:36864
    s_add_u32 s74, s73, 1
    s_cmp_eq_u32 s74, s13
    s_cselect_b32 s74, s12, s74
    s_add_u32 s75, s74, 1
    v_mfma_f32_32x32x16_bf16 v[32:47], a[4:7], a[8:11], v[32:47]
    ds_read_b64_tr_b16 a[36:37], v85 offset:40960
    ds_read_b64_tr_b16 a[38:39], v85 offset:41984
    s_cmp_eq_u32 s75, s13
    s_cselect_b32 s75, s12, s75
    s_add_u32 s76, s75, 1
    s_cmp_eq_u32 s76, s13
    s_cselect_b32 s76, s12, s76
    v_mfma_f32_32x32x16_bf16 v[48:63], a[4:7], a[12:15], v[48:63]
    v_mfma_f32_16x16x32_bf16 v[64:67], a[0:3], v[96:99], v[64:67]
    ds_read_b128 a[56:59], v83 offset:32768
    ds_read_b64_tr_b16 a[48:49], v84 offset:45056
    s_add_u32 s77, s76, 1
    s_cmp_eq_u32 s77, s13
    s_cselect_b32 s77, s12, s77
    s_add_u32 s78, s77, 1
    s_waitcnt lgkmcnt(8)
    v_mfma_f32_32x32x16_bf16 v[0:15], a[16:19], a[24:27], v[0:15]
    ds_read_b64_tr_b16 a[50:51], v84 offset:46080
    ds_read_b128 a[60:63], v83 offset:36864
    s_cmp_eq_u32 s78, s13
    s_cselect_b32 s78, s12, s78
    s_add_u32 s79, s78, 1
    s_cmp_eq_u32 s79, s13
    s_cselect_b32 s79, s12, s79
    v_mfma_f32_32x32x16_bf16 v[16:31], a[16:19], a[28:31], v[16:31]
    ds_read_b64_tr_b16 a[52:53], v85 offset:45056
    ds_read_b64_tr_b16 a[54:55], v85 offset:46080
    s_add_u32 s80, s79, 1
    s_cmp_eq_u32 s80, s13
    s_cselect_b32 s80, s12, s80
    s_add_u32 s81, s80, 1
    v_mfma_f32_32x32x16_bf16 v[32:47], a[20:23], a[24:27], v[32:47]
    s_cmp_eq_u32 s81, s13
    s_cselect_b32 s81, s12, s81
    s_add_u32 s82, s81, 1
    s_cmp_eq_u32 s82, s13
    s_cselect_b32 s82, s12, s82
    v_mfma_f32_32x32x16_bf16 v[48:63], a[20:23], a[28:31], v[48:63]
    v_mfma_f32_16x16x32_bf16 v[64:67], a[16:19], v[96:99], v[64:67]
    s_add_u32 s83, s82, 1
    s_cmp_eq_u32 s83, s13
    s_cselect_b32 s83, s12, s83
    s_add_u32 s84, s83, 1
    s_waitcnt vmcnt(3)
    s_waitcnt lgkmcnt(0)
    ds_write_b32 v72, v74
    v_mfma_f32_32x32x16_bf16 v[0:15], a[32:35], a[40:43], v[0:15]
    v_mfma_f32_32x32x16_bf16 v[16:31], a[32:35], a[44:47], v[16:31]
    v_mfma_f32_32x32x16_bf16 v[32:47], a[36:39], a[40:43], v[32:47]
    ds_read_b32 v75, v73
    v_mov_b32 v74, 11
    v_mfma_f32_32x32x16_bf16 v[48:63], a[36:39], a[44:47], v[48:63]
    v_mfma_f32_16x16x32_bf16 v[64:67], a[32:35], v[96:99], v[64:67]
    v_mfma_f32_32x32x16_bf16 v[0:15], a[48:51], a[56:59], v[0:15]
    s_waitcnt lgkmcnt(0)
    v_cmp_gt_u32 vcc, 10, v75
    s_cbranch_vccnz L_slow_28
L_go_29:
    ds_read_b128 a[8:11], v80 offset:0
    ds_read_b64_tr_b16 a[0:1], v84 offset:0
    ds_read_b64_tr_b16 a[2:3], v84 offset:1024
    ds_read_b128 a[12:15], v80 offset:4096
    ds_read_b64_tr_b16 a[4:5], v85 offset:0
    ds_read_b64_tr_b16 a[6:7], v85 offset:1024
    v_mfma_f32_32x32x16_bf16 v[16:31], a[48:51], a[60:63], v[16:31]
    ds_read_b128 a[24:27], v81 offset:0
    ds_read_b64_tr_b16 a[16:17], v84 offset:4096
    s_cmp_eq_u32 s84, s13
    s_cselect_b32 s84, s12, s84
    s_add_u32 s85, s84, 1
    s_cmp_eq_u32 s85, s13
    s_cselect_b32 s85, s12, s85
    v_mfma_f32_32x32x16_bf16 v[32:47], a[52:55], a[56:59], v[32:47]
    ds_read_b64_tr_b16 a[18:19], v84 offset:5120
    ds_read_b128 a[28:31], v81 offset:4096
    s_cmp_ge_u32 s63, 2
    s_cselect_b32 s85, 0x2000, s85
    s_mul_i32 s62, s65, 276480
    s_add_u32 s62, s62, 3145728
    v_mfma_f32_32x32x16_bf16 v[48:63], a[52:55], a[60:63], v[48:63]
    v_mfma_f32_16x16x32_bf16 v[64:67], a[48:51], v[96:99], v[64:67]
    ds_read_b64_tr_b16 a[20:21], v85 offset:4096
    ds_read_b64_tr_b16 a[22:23], v85 offset:5120
    s_mul_i32 s61, s64, 221184
    s_add_u32 s61, s61, 6291456
    v_lshlrev_b32 v124, 4, v127
    v_add_u32 v125, 4096, v124
    s_waitcnt lgkmcnt(6)
    v_mfma_f32_32x32x16_bf16 v[0:15], a[0:3], a[8:11], v[0:15]
    ds_read_b128 a[40:43], v82 offset:0
    ds_read_b64_tr_b16 a[32:33], v84 offset:8192
    s_lshl_b32 s68, s63, 12
    v_add_u32 v126, s68, v124
    v_add_u32 v126, 16384, v126
    v_mfma_f32_32x32x16_bf16 v[16:31], a[0:3], a[12:15], v[16:31]
    ds_read_b64_tr_b16 a[34:35], v84 offset:9216
    ds_read_b128 a[44:47], v82 offset:4096
    v_mfma_f32_32x32x16_bf16 v[32:47], a[4:7], a[8:11], v[32:47]
    ds_read_b64_tr_b16 a[36:37], v85 offset:8192
    ds_read_b64_tr_b16 a[38:39], v85 offset:9216
    v_mfma_f32_32x32x16_bf16 v[48:63], a[4:7], a[12:15], v[48:63]
    v_mfma_f32_16x16x32_bf16 v[64:67], a[0:3], v[96:99], v[64:67]
    ds_read_b128 a[56:59], v83 offset:0
    ds_read_b64_tr_b16 a[48:49], v84 offset:12288
    s_waitcnt lgkmcnt(8)
    v_mfma_f32_32x32x16_bf16 v[0:15], a[16:19], a[24:27], v[0:15]
    ds_read_b64_tr_b16 a[50:51], v84 offset:13312
    ds_read_b128 a[60:63], v83 offset:4096
    v_mfma_f32_32x32x16_bf16 v[16:31], a[16:19], a[28:31], v[16:31]
    ds_read_b64_tr_b16 a[52:53], v85 offset:12288
    ds_read_b64_tr_b16 a[54:55], v85 offset:13312
    v_mfma_f32_32x32x16_bf16 v[32:47], a[20:23], a[24:27], v[32:47]
    v_mfma_f32_32x32x16_bf16 v[48:63], a[20:23], a[28:31], v[48:63]
    v_mfma_f32_16x16x32_bf16 v[64:67], a[16:19], v[96:99], v[64:67]
    s_waitcnt lgkmcnt(6)
    v_mfma_f32_32x32x16_bf16 v[0:15], a[32:35], a[40:43], v[0:15]
    v_mfma_f32_32x32x16_bf16 v[16:31], a[32:35], a[44:47], v[16:31]
    v_mfma_f32_32x32x16_bf16 v[32:47], a[36:39], a[40:43], v[32:47]
    v_mfma_f32_32x32x16_bf16 v[48:63], a[36:39], a[44:47], v[48:63]
    v_mfma_f32_16x16x32_bf16 v[64:67], a[32:35], v[96:99], v[64:67]
    s_waitcnt lgkmcnt(0)
    v_mfma_f32_32x32x16_bf16 v[0:15], a[48:51], a[56:59], v[0:15]
    v_mfma_f32_16x16x32_bf16 v[64:67], a[48:51], v[96:99], v[64:67]
    v_mfma_f32_32x32x16_bf16 v[16:31], a[48:51], a[60:63], v[16:31]
    s_lshl_b32 s69, s63, 7
    s_add_u32 s69, s69, 92160
    v_bfe_u32 v116, v127, 3, 1
    v_lshlrev_b32 v116, 6, v116
    v_lshl_add_u32 v116, v117, 4, v116
    v_add_u32 v116, s69, v116
    v_mfma_f32_32x32x16_bf16 v[32:47], a[52:55], a[56:59], v[32:47]
    v_and_b32 v118, 31, v127
    v_lshl_add_u32 v118, v118, 2, s69
    v_lshlrev_b32 v100, 16, v100
    ds_write_b128 v116, v[64:67]
    v_mov_b32 v119, 0
    ds_write_b32 v118, v100 offset:512
    ds_write_b32 v118, v119 offset:1024
    ds_write_b32 v72, v74
    v_mfma_f32_32x32x16_bf16 v[48:63], a[52:55], a[60:63], v[48:63]
    v_lshrrev_b32 v118, 5, v127
    v_lshl_add_u32 v116, v118, 4, s69
    v_xor_b32 v119, 128, v116
    ds_read_b32 v75, v73
    s_waitcnt lgkmcnt(0)
    v_cmp_gt_u32 vcc, 11, v75
    s_cbranch_vccnz L_slow_31
L_go_32:
    ds_read_b128 v[64:67], v116 offset:0
    ds_read_b128 v[80:83], v116 offset:512
    ds_read_b128 v[68:71], v116 offset:32
    ds_read_b128 v[84:87], v116 offset:544
    ds_read_b128 v[72:75], v116 offset:64
    ds_read_b128 v[88:91], v116 offset:576
    ds_read_b128 v[76:79], v116 offset:96
    ds_read_b128 v[92:95], v116 offset:608
    s_lshl_b32 s69, s56, 1
    s_add_u32 s69, s69, s66
    s_mul_i32 s70, s69, 54
    s_lshl_b32 s7, s58, 1
    s_add_u32 s7, s7, s67
    s_lshl_b32 s69, s69, 5
    s_add_u32 s6, s69, s7
    s_lshl_b32 s6, s6, 7
    s_add_u32 s6, s6, 2752512
    s_cmp_ge_u32 s7, 27
    s_cbranch_scc1 L_skipg
    s_lshl_b32 s7, s7, 1
    s_add_u32 s70, s70, s7
    s_add_u32 s4, s70, s66
    s_xor_b32 s66, s66, 1
    s_add_u32 s5, s70, s66
    s_lshl_b32 s4, s4, 12
    s_lshl_b32 s5, s5, 12
    s_add_u32 s4, s4, 6291456
    s_add_u32 s5, s5, 6291456
    v_and_b32 v116, 15, v127
    v_lshlrev_b32 v116, 4, v116
    v_lshl_add_u32 v116, v118, 8, v116
    v_and_b32 v117, 1, v117
    v_lshl_add_u32 v116, v117, 10, v116
    s_mov_b32 s8, 0xbdd2d3e8
    s_mov_b32 s9, s8
    s_mov_b32 s10, 1.0
    s_mov_b32 s11, 1.0
    v_mov_b32 v112, 0xc0135761
    v_mov_b32 v113, v112
    s_waitcnt vmcnt(1)
    s_mov_b32 s71, 40000
L_poll_34:
    v_min_u32 v103, v109, v111
    v_cmp_eq_u32 vcc, 0, v103
    s_cbranch_vccz L_ok_35
    buffer_load_dwordx2 v[108:109], v102, s[44:47], s19 offen offset:0 sc0 sc1
    buffer_load_dwordx2 v[110:111], v102, s[44:47], s19 offen offset:512 sc0 sc1
    s_sub_u32 s71, s71, 1
    s_waitcnt vmcnt(0)
    s_cbranch_scc0 L_poll_34
L_ok_35:
    s_waitcnt lgkmcnt(0)
    v_pk_fma_f32 v[0:1], v[108:109], v[64:65], v[0:1] op_sel_hi:[0,1,1] neg_lo:[1,0,0] neg_hi:[1,0,0]
    v_pk_fma_f32 v[2:3], v[108:109], v[66:67], v[2:3] op_sel_hi:[0,1,1] neg_lo:[1,0,0] neg_hi:[1,0,0]
    v_pk_fma_f32 v[4:5], v[108:109], v[68:69], v[4:5] op_sel_hi:[0,1,1] neg_lo:[1,0,0] neg_hi:[1,0,0]
    v_pk_fma_f32 v[6:7], v[108:109], v[70:71], v[6:7] op_sel_hi:[0,1,1] neg_lo:[1,0,0] neg_hi:[1,0,0]
    v_pk_fma_f32 v[0:1], v[108:109], v[0:1], v[80:81] op_sel:[1,0,0]
    v_pk_fma_f32 v[2:3], v[108:109], v[2:3], v[82:83] op_sel:[1,0,0]
    v_pk_fma_f32 v[4:5], v[108:109], v[4:5], v[84:85] op_sel:[1,0,0]
    v_pk_fma_f32 v[6:7], v[108:109], v[6:7], v[86:87] op_sel:[1,0,0]
    v_pk_mul_f32 v[96:97], v[0:1], v[0:1]
    v_pk_mul_f32 v[98:99], v[2:3], v[2:3]
    v_pk_mul_f32 v[100:101], v[4:5], v[4:5]
    v_pk_mul_f32 v[102:103], v[6:7], v[6:7]
    v_pk_fma_f32 v[96:97], v[96:97], s[8:9], v[112:113]
    v_pk_fma_f32 v[98:99], v[98:99], s[8:9], v[112:113]
    v_pk_fma_f32 v[100:101], v[100:101], s[8:9], v[112:113]
    v_pk_fma_f32 v[102:103], v[102:103], s[8:9], v[112:113]
    v_pk_mul_f32 v[96:97], v[96:97], v[0:1]
    v_pk_mul_f32 v[98:99], v[98:99], v[2:3]
    v_pk_mul_f32 v[100:101], v[100:101], v[4:5]
    v_pk_mul_f32 v[102:103], v[102:103], v[6:7]
    v_exp_f32 v96, v96
    v_exp_f32 v97, v97
    v_exp_f32 v98, v98
    v_exp_f32 v99, v99
    v_exp_f32 v100, v100
    v_exp_f32 v101, v101
    v_exp_f32 v102, v102
    v_exp_f32 v103, v103
    v_pk_add_f32 v[96:97], v[96:97], s[10:11]
    v_pk_add_f32 v[98:99], v[98:99], s[10:11]
    v_pk_add_f32 v[100:101], v[100:101], s[10:11]
    v_pk_add_f32 v[102:103], v[102:103], s[10:11]
    v_rcp_f32 v96, v96
    v_rcp_f32 v97, v97
    v_rcp_f32 v98, v98
    v_rcp_f32 v99, v99
    v_rcp_f32 v100, v100
    v_rcp_f32 v101, v101
    v_rcp_f32 v102, v102
    v_rcp_f32 v103, v103
    v_pk_mul_f32 v[96:97], v[96:97], v[0:1]
    v_pk_mul_f32 v[98:99], v[98:99], v[2:3]
    v_pk_mul_f32 v[100:101], v[100:101], v[4:5]
    v_pk_mul_f32 v[102:103], v[102:103], v[6:7]
    v_cvt_pk_bf16_f32 v104, v96, v97
    v_cvt_pk_bf16_f32 v105, v98, v99
    v_cvt_pk_bf16_f32 v106, v100, v101
    v_cvt_pk_bf16_f32 v107, v102, v103
    buffer_store_dwordx4 v[104:107], v116, s[44:47], s4 offen offset:0 sc1
    v_pk_fma_f32 v[8:9], v[108:109], v[72:73], v[8:9] op_sel_hi:[0,1,1] neg_lo:[1,0,0] neg_hi:[1,0,0]
    v_pk_fma_f32 v[10:11], v[108:109], v[74:75], v[10:11] op_sel_hi:[0,1,1] neg_lo:[1,0,0] neg_hi:[1,0,0]
    v_pk_fma_f32 v[12:13], v[108:109], v[76:77], v[12:13] op_sel_hi:[0,1,1] neg_lo:[1,0,0] neg_hi:[1,0,0]
    v_pk_fma_f32 v[14:15], v[108:109], v[78:79], v[14:15] op_sel_hi:[0,1,1] neg_lo:[1,0,0] neg_hi:[1,0,0]
    v_pk_fma_f32 v[8:9], v[108:109], v[8:9], v[88:89] op_sel:[1,0,0]
    v_pk_fma_f32 v[10:11], v[108:109], v[10:11], v[90:91] op_sel:[1,0,0]
    v_pk_fma_f32 v[12:13], v[108:109], v[12:13], v[92:93] op_sel:[1,0,0]
    v_pk_fma_f32 v[14:15], v[108:109], v[14:15], v[94:95] op_sel:[1,0,0]
    v_pk_mul_f32 v[96:97], v[8:9], v[8:9]
    v_pk_mul_f32 v[98:99], v[10:11], v[10:11]
    v_pk_mul_f32 v[100:101], v[12:13], v[12:13]
    v_pk_mul_f32 v[102:103], v[14:15], v[14:15]
    v_pk_fma_f32 v[96:97], v[96:97], s[8:9], v[112:113]
    v_pk_fma_f32 v[98:99], v[98:99], s[8:9], v[112:113]
    v_pk_fma_f32 v[100:101], v[100:101], s[8:9], v[112:113]
    v_pk_fma_f32 v[102:103], v[102:103], s[8:9], v[112:113]
    v_pk_mul_f32 v[96:97], v[96:97], v[8:9]
    v_pk_mul_f32 v[98:99], v[98:99], v[10:11]
    v_pk_mul_f32 v[100:101], v[100:101], v[12:13]
    v_pk_mul_f32 v[102:103], v[102:103], v[14:15]
    v_exp_f32 v96, v96
    v_exp_f32 v97, v97
    v_exp_f32 v98, v98
    v_exp_f32 v99, v99
    v_exp_f32 v100, v100
    v_exp_f32 v101, v101
    v_exp_f32 v102, v102
    v_exp_f32 v103, v103
    v_pk_add_f32 v[96:97], v[96:97], s[10:11]
    v_pk_add_f32 v[98:99], v[98:99], s[10:11]
    v_pk_add_f32 v[100:101], v[100:101], s[10:11]
    v_pk_add_f32 v[102:103], v[102:103], s[10:11]
    v_rcp_f32 v96, v96
    v_rcp_f32 v97, v97
    v_rcp_f32 v98, v98
    v_rcp_f32 v99, v99
    v_rcp_f32 v100, v100
    v_rcp_f32 v101, v101
    v_rcp_f32 v102, v102
    v_rcp_f32 v103, v103
    v_pk_mul_f32 v[96:97], v[96:97], v[8:9]
    v_pk_mul_f32 v[98:99], v[98:99], v[10:11]
    v_pk_mul_f32 v[100:101], v[100:101], v[12:13]
    v_pk_mul_f32 v[102:103], v[102:103], v[14:15]
    v_cvt_pk_bf16_f32 v120, v96, v97
    v_cvt_pk_bf16_f32 v121, v98, v99
    v_cvt_pk_bf16_f32 v122, v100, v101
    v_cvt_pk_bf16_f32 v123, v102, v103
    buffer_store_dwordx4 v[120:123], v116, s[44:47], s4 offen offset:512 sc1
    v_pk_fma_f32 v[16:17], v[110:111], v[64:65], v[16:17] op_sel_hi:[0,1,1] neg_lo:[1,0,0] neg_hi:[1,0,0]
    v_pk_fma_f32 v[18:19], v[110:111], v[66:67], v[18:19] op_sel_hi:[0,1,1] neg_lo:[1,0,0] neg_hi:[1,0,0]
    v_pk_fma_f32 v[20:21], v[110:111], v[68:69], v[20:21] op_sel_hi:[0,1,1] neg_lo:[1,0,0] neg_hi:[1,0,0]
    v_pk_fma_f32 v[22:23], v[110:111], v[70:71], v[22:23] op_sel_hi:[0,1,1] neg_lo:[1,0,0] neg_hi:[1,0,0]
    v_pk_fma_f32 v[16:17], v[110:111], v[16:17], v[80:81] op_sel:[1,0,0]
    v_pk_fma_f32 v[18:19], v[110:111], v[18:19], v[82:83] op_sel:[1,0,0]
    v_pk_fma_f32 v[20:21], v[110:111], v[20:21], v[84:85] op_sel:[1,0,0]
    v_pk_fma_f32 v[22:23], v[110:111], v[22:23], v[86:87] op_sel:[1,0,0]
    v_pk_mul_f32 v[96:97], v[16:17], v[16:17]
    v_pk_mul_f32 v[98:99], v[18:19], v[18:19]
    v_pk_mul_f32 v[100:101], v[20:21], v[20:21]
    v_pk_mul_f32 v[102:103], v[22:23], v[22:23]
    v_pk_fma_f32 v[96:97], v[96:97], s[8:9], v[112:113]
    v_pk_fma_f32 v[98:99], v[98:99], s[8:9], v[112:113]
    v_pk_fma_f32 v[100:101], v[100:101], s[8:9], v[112:113]
    v_pk_fma_f32 v[102:103], v[102:103], s[8:9], v[112:113]
    v_pk_mul_f32 v[96:97], v[96:97], v[16:17]
    v_pk_mul_f32 v[98:99], v[98:99], v[18:19]
    v_pk_mul_f32 v[100:101], v[100:101], v[20:21]
    v_pk_mul_f32 v[102:103], v[102:103], v[22:23]
    v_exp_f32 v96, v96
    v_exp_f32 v97, v97
    v_exp_f32 v98, v98
    v_exp_f32 v99, v99
    v_exp_f32 v100, v100
    v_exp_f32 v101, v101
    v_exp_f32 v102, v102
    v_exp_f32 v103, v103
    v_pk_add_f32 v[96:97], v[96:97], s[10:11]
    v_pk_add_f32 v[98:99], v[98:99], s[10:11]
    v_pk_add_f32 v[100:101], v[100:101], s[10:11]
    v_pk_add_f32 v[102:103], v[102:103], s[10:11]
    v_rcp_f32 v96, v96
    v_rcp_f32 v97, v97
    v_rcp_f32 v98, v98
    v_rcp_f32 v99, v99
    v_rcp_f32 v100, v100
    v_rcp_f32 v101, v101
    v_rcp_f32 v102, v102
    v_rcp_f32 v103, v103
    v_pk_mul_f32 v[96:97], v[96:97], v[16:17]
    v_pk_mul_f32 v[98:99], v[98:99], v[18:19]
    v_pk_mul_f32 v[100:101], v[100:101], v[20:21]
    v_pk_mul_f32 v[102:103], v[102:103], v[22:23]
    v_cvt_pk_bf16_f32 v104, v96, v97
    v_cvt_pk_bf16_f32 v105, v98, v99
    v_cvt_pk_bf16_f32 v106, v100, v101
    v_cvt_pk_bf16_f32 v107, v102, v103
    buffer_store_dwordx4 v[104:107], v116, s[44:47], s4 offen offset:2048 sc1
    v_pk_fma_f32 v[24:25], v[110:111], v[72:73], v[24:25] op_sel_hi:[0,1,1] neg_lo:[1,0,0] neg_hi:[1,0,0]
    v_pk_fma_f32 v[26:27], v[110:111], v[74:75], v[26:27] op_sel_hi:[0,1,1] neg_lo:[1,0,0] neg_hi:[1,0,0]
    v_pk_fma_f32 v[28:29], v[110:111], v[76:77], v[28:29] op_sel_hi:[0,1,1] neg_lo:[1,0,0] neg_hi:[1,0,0]
    v_pk_fma_f32 v[30:31], v[110:111], v[78:79], v[30:31] op_sel_hi:[0,1,1] neg_lo:[1,0,0] neg_hi:[1,0,0]
    v_pk_fma_f32 v[24:25], v[110:111], v[24:25], v[88:89] op_sel:[1,0,0]
    v_pk_fma_f32 v[26:27], v[110:111], v[26:27], v[90:91] op_sel:[1,0,0]
    v_pk_fma_f32 v[28:29], v[110:111], v[28:29], v[92:93] op_sel:[1,0,0]
    v_pk_fma_f32 v[30:31], v[110:111], v[30:31], v[94:95] op_sel:[1,0,0]
    ds_read_b128 v[64:67], v119 offset:0
    ds_read_b128 v[80:83], v119 offset:512
    ds_read_b128 v[68:71], v119 offset:32
    ds_read_b128 v[84:87], v119 offset:544
    ds_read_b128 v[72:75], v119 offset:64
    ds_read_b128 v[88:91], v119 offset:576
    ds_read_b128 v[76:79], v119 offset:96
    ds_read_b128 v[92:95], v119 offset:608
    v_pk_mul_f32 v[96:97], v[24:25], v[24:25]
    v_pk_mul_f32 v[98:99], v[26:27], v[26:27]
    v_pk_mul_f32 v[100:101], v[28:29], v[28:29]
    v_pk_mul_f32 v[102:103], v[30:31], v[30:31]
    v_pk_fma_f32 v[96:97], v[96:97], s[8:9], v[112:113]
    v_pk_fma_f32 v[98:99], v[98:99], s[8:9], v[112:113]
    v_pk_fma_f32 v[100:101], v[100:101], s[8:9], v[112:113]
    v_pk_fma_f32 v[102:103], v[102:103], s[8:9], v[112:113]
    v_pk_mul_f32 v[96:97], v[96:97], v[24:25]
    v_pk_mul_f32 v[98:99], v[98:99], v[26:27]
    v_pk_mul_f32 v[100:101], v[100:101], v[28:29]
    v_pk_mul_f32 v[102:103], v[102:103], v[30:31]
    v_exp_f32 v96, v96
    v_exp_f32 v97, v97
    v_exp_f32 v98, v98
    v_exp_f32 v99, v99
    v_exp_f32 v100, v100
    v_exp_f32 v101, v101
    v_exp_f32 v102, v102
    v_exp_f32 v103, v103
    v_pk_add_f32 v[96:97], v[96:97], s[10:11]
    v_pk_add_f32 v[98:99], v[98:99], s[10:11]
    v_pk_add_f32 v[100:101], v[100:101], s[10:11]
    v_pk_add_f32 v[102:103], v[102:103], s[10:11]
    v_rcp_f32 v96, v96
    v_rcp_f32 v97, v97
    v_rcp_f32 v98, v98
    v_rcp_f32 v99, v99
    v_rcp_f32 v100, v100
    v_rcp_f32 v101, v101
    v_rcp_f32 v102, v102
    v_rcp_f32 v103, v103
    v_pk_mul_f32 v[96:97], v[96:97], v[24:25]
    v_pk_mul_f32 v[98:99], v[98:99], v[26:27]
    v_pk_mul_f32 v[100:101], v[100:101], v[28:29]
    v_pk_mul_f32 v[102:103], v[102:103], v[30:31]
    v_cvt_pk_bf16_f32 v120, v96, v97
    v_cvt_pk_bf16_f32 v121, v98, v99
    v_cvt_pk_bf16_f32 v122, v100, v101
    v_cvt_pk_bf16_f32 v123, v102, v103
    buffer_store_dwordx4 v[120:123], v116, s[44:47], s4 offen offset:2560 sc1
    s_waitcnt lgkmcnt(0)
    v_pk_fma_f32 v[32:33], v[108:109], v[64:65], v[32:33] op_sel_hi:[0,1,1] neg_lo:[1,0,0] neg_hi:[1,0,0]
    v_pk_fma_f32 v[34:35], v[108:109], v[66:67], v[34:35] op_sel_hi:[0,1,1] neg_lo:[1,0,0] neg_hi:[1,0,0]
    v_pk_fma_f32 v[36:37], v[108:109], v[68:69], v[36:37] op_sel_hi:[0,1,1] neg_lo:[1,0,0] neg_hi:[1,0,0]
    v_pk_fma_f32 v[38:39], v[108:109], v[70:71], v[38:39] op_sel_hi:[0,1,1] neg_lo:[1,0,0] neg_hi:[1,0,0]
    v_pk_fma_f32 v[32:33], v[108:109], v[32:33], v[80:81] op_sel:[1,0,0]
    v_pk_fma_f32 v[34:35], v[108:109], v[34:35], v[82:83] op_sel:[1,0,0]
    v_pk_fma_f32 v[36:37], v[108:109], v[36:37], v[84:85] op_sel:[1,0,0]
    v_pk_fma_f32 v[38:39], v[108:109], v[38:39], v[86:87] op_sel:[1,0,0]
    v_pk_mul_f32 v[96:97], v[32:33], v[32:33]
    v_pk_mul_f32 v[98:99], v[34:35], v[34:35]
    v_pk_mul_f32 v[100:101], v[36:37], v[36:37]
    v_pk_mul_f32 v[102:103], v[38:39], v[38:39]
    v_pk_fma_f32 v[96:97], v[96:97], s[8:9], v[112:113]
    v_pk_fma_f32 v[98:99], v[98:99], s[8:9], v[112:113]
    v_pk_fma_f32 v[100:101], v[100:101], s[8:9], v[112:113]
    v_pk_fma_f32 v[102:103], v[102:103], s[8:9], v[112:113]
    v_pk_mul_f32 v[96:97], v[96:97], v[32:33]
    v_pk_mul_f32 v[98:99], v[98:99], v[34:35]
    v_pk_mul_f32 v[100:101], v[100:101], v[36:37]
    v_pk_mul_f32 v[102:103], v[102:103], v[38:39]
    v_exp_f32 v96, v96
    v_exp_f32 v97, v97
    v_exp_f32 v98, v98
    v_exp_f32 v99, v99
    v_exp_f32 v100, v100
    v_exp_f32 v101, v101
    v_exp_f32 v102, v102
    v_exp_f32 v103, v103
    v_pk_add_f32 v[96:97], v[96:97], s[10:11]
    v_pk_add_f32 v[98:99], v[98:99], s[10:11]
    v_pk_add_f32 v[100:101], v[100:101], s[10:11]
    v_pk_add_f32 v[102:103], v[102:103], s[10:11]
    v_rcp_f32 v96, v96
    v_rcp_f32 v97, v97
    v_rcp_f32 v98, v98
    v_rcp_f32 v99, v99
    v_rcp_f32 v100, v100
    v_rcp_f32 v101, v101
    v_rcp_f32 v102, v102
    v_rcp_f32 v103, v103
    v_pk_mul_f32 v[96:97], v[96:97], v[32:33]
    v_pk_mul_f32 v[98:99], v[98:99], v[34:35]
    v_pk_mul_f32 v[100:101], v[100:101], v[36:37]
    v_pk_mul_f32 v[102:103], v[102:103], v[38:39]
    v_cvt_pk_bf16_f32 v104, v96, v97
    v_cvt_pk_bf16_f32 v105, v98, v99
    v_cvt_pk_bf16_f32 v106, v100, v101
    v_cvt_pk_bf16_f32 v107, v102, v103
    buffer_store_dwordx4 v[104:107], v116, s[44:47], s5 offen offset:0 sc1
    v_pk_fma_f32 v[40:41], v[108:109], v[72:73], v[40:41] op_sel_hi:[0,1,1] neg_lo:[1,0,0] neg_hi:[1,0,0]
    v_pk_fma_f32 v[42:43], v[108:109], v[74:75], v[42:43] op_sel_hi:[0,1,1] neg_lo:[1,0,0] neg_hi:[1,0,0]
    v_pk_fma_f32 v[44:45], v[108:109], v[76:77], v[44:45] op_sel_hi:[0,1,1] neg_lo:[1,0,0] neg_hi:[1,0,0]
    v_pk_fma_f32 v[46:47], v[108:109], v[78:79], v[46:47] op_sel_hi:[0,1,1] neg_lo:[1,0,0] neg_hi:[1,0,0]
    v_pk_fma_f32 v[40:41], v[108:109], v[40:41], v[88:89] op_sel:[1,0,0]
    v_pk_fma_f32 v[42:43], v[108:109], v[42:43], v[90:91] op_sel:[1,0,0]
    v_pk_fma_f32 v[44:45], v[108:109], v[44:45], v[92:93] op_sel:[1,0,0]
    v_pk_fma_f32 v[46:47], v[108:109], v[46:47], v[94:95] op_sel:[1,0,0]
    v_pk_mul_f32 v[96:97], v[40:41], v[40:41]
    v_pk_mul_f32 v[98:99], v[42:43], v[42:43]
    v_pk_mul_f32 v[100:101], v[44:45], v[44:45]
    v_pk_mul_f32 v[102:103], v[46:47], v[46:47]
    v_pk_fma_f32 v[96:97], v[96:97], s[8:9], v[112:113]
    v_pk_fma_f32 v[98:99], v[98:99], s[8:9], v[112:113]
    v_pk_fma_f32 v[100:101], v[100:101], s[8:9], v[112:113]
    v_pk_fma_f32 v[102:103], v[102:103], s[8:9], v[112:113]
    v_pk_mul_f32 v[96:97], v[96:97], v[40:41]
    v_pk_mul_f32 v[98:99], v[98:99], v[42:43]
    v_pk_mul_f32 v[100:101], v[100:101], v[44:45]
    v_pk_mul_f32 v[102:103], v[102:103], v[46:47]
    v_exp_f32 v96, v96
    v_exp_f32 v97, v97
    v_exp_f32 v98, v98
    v_exp_f32 v99, v99
    v_exp_f32 v100, v100
    v_exp_f32 v101, v101
    v_exp_f32 v102, v102
    v_exp_f32 v103, v103
    v_pk_add_f32 v[96:97], v[96:97], s[10:11]
    v_pk_add_f32 v[98:99], v[98:99], s[10:11]
    v_pk_add_f32 v[100:101], v[100:101], s[10:11]
    v_pk_add_f32 v[102:103], v[102:103], s[10:11]
    v_rcp_f32 v96, v96
    v_rcp_f32 v97, v97
    v_rcp_f32 v98, v98
    v_rcp_f32 v99, v99
    v_rcp_f32 v100, v100
    v_rcp_f32 v101, v101
    v_rcp_f32 v102, v102
    v_rcp_f32 v103, v103
    v_pk_mul_f32 v[96:97], v[96:97], v[40:41]
    v_pk_mul_f32 v[98:99], v[98:99], v[42:43]
    v_pk_mul_f32 v[100:101], v[100:101], v[44:45]
    v_pk_mul_f32 v[102:103], v[102:103], v[46:47]
    v_cvt_pk_bf16_f32 v120, v96, v97
    v_cvt_pk_bf16_f32 v121, v98, v99
    v_cvt_pk_bf16_f32 v122, v100, v101
    buffer_load_dword v114, v115, s[44:47], 0 offen sc0 sc1
    v_cvt_pk_bf16_f32 v123, v102, v103
    buffer_store_dwordx4 v[120:123], v116, s[44:47], s5 offen offset:512 sc1
    v_pk_fma_f32 v[48:49], v[110:111], v[64:65], v[48:49] op_sel_hi:[0,1,1] neg_lo:[1,0,0] neg_hi:[1,0,0]
    v_pk_fma_f32 v[50:51], v[110:111], v[66:67], v[50:51] op_sel_hi:[0,1,1] neg_lo:[1,0,0] neg_hi:[1,0,0]
    v_pk_fma_f32 v[52:53], v[110:111], v[68:69], v[52:53] op_sel_hi:[0,1,1] neg_lo:[1,0,0] neg_hi:[1,0,0]
    v_pk_fma_f32 v[54:55], v[110:111], v[70:71], v[54:55] op_sel_hi:[0,1,1] neg_lo:[1,0,0] neg_hi:[1,0,0]
    v_pk_fma_f32 v[48:49], v[110:111], v[48:49], v[80:81] op_sel:[1,0,0]
    v_pk_fma_f32 v[50:51], v[110:111], v[50:51], v[82:83] op_sel:[1,0,0]
    v_pk_fma_f32 v[52:53], v[110:111], v[52:53], v[84:85] op_sel:[1,0,0]
    v_pk_fma_f32 v[54:55], v[110:111], v[54:55], v[86:87] op_sel:[1,0,0]
    v_pk_mul_f32 v[96:97], v[48:49], v[48:49]
    v_pk_mul_f32 v[98:99], v[50:51], v[50:51]
    v_pk_mul_f32 v[100:101], v[52:53], v[52:53]
    v_pk_mul_f32 v[102:103], v[54:55], v[54:55]
    v_pk_fma_f32 v[96:97], v[96:97], s[8:9], v[112:113]
    v_pk_fma_f32 v[98:99], v[98:99], s[8:9], v[112:113]
    v_pk_fma_f32 v[100:101], v[100:101], s[8:9], v[112:113]
    v_pk_fma_f32 v[102:103], v[102:103], s[8:9], v[112:113]
    v_pk_mul_f32 v[96:97], v[96:97], v[48:49]
    v_pk_mul_f32 v[98:99], v[98:99], v[50:51]
    v_pk_mul_f32 v[100:101], v[100:101], v[52:53]
    v_pk_mul_f32 v[102:103], v[102:103], v[54:55]
    v_exp_f32 v96, v96
    v_exp_f32 v97, v97
    v_exp_f32 v98, v98
    v_exp_f32 v99, v99
    v_exp_f32 v100, v100
    v_exp_f32 v101, v101
    v_exp_f32 v102, v102
    v_exp_f32 v103, v103
    v_pk_add_f32 v[96:97], v[96:97], s[10:11]
    v_pk_add_f32 v[98:99], v[98:99], s[10:11]
    v_pk_add_f32 v[100:101], v[100:101], s[10:11]
    v_pk_add_f32 v[102:103], v[102:103], s[10:11]
    v_rcp_f32 v96, v96
    v_rcp_f32 v97, v97
    v_rcp_f32 v98, v98
    v_rcp_f32 v99, v99
    v_rcp_f32 v100, v100
    v_rcp_f32 v101, v101
    v_rcp_f32 v102, v102
    v_rcp_f32 v103, v103
    v_pk_mul_f32 v[96:97], v[96:97], v[48:49]
    v_pk_mul_f32 v[98:99], v[98:99], v[50:51]
    v_pk_mul_f32 v[100:101], v[100:101], v[52:53]
    v_pk_mul_f32 v[102:103], v[102:103], v[54:55]
    v_cvt_pk_bf16_f32 v104, v96, v97
    v_cvt_pk_bf16_f32 v105, v98, v99
    v_cvt_pk_bf16_f32 v106, v100, v101
    v_cvt_pk_bf16_f32 v107, v102, v103
    buffer_store_dwordx4 v[104:107], v116, s[44:47], s5 offen offset:2048 sc1
    v_pk_fma_f32 v[56:57], v[110:111], v[72:73], v[56:57] op_sel_hi:[0,1,1] neg_lo:[1,0,0] neg_hi:[1,0,0]
    v_pk_fma_f32 v[58:59], v[110:111], v[74:75], v[58:59] op_sel_hi:[0,1,1] neg_lo:[1,0,0] neg_hi:[1,0,0]
    v_pk_fma_f32 v[60:61], v[110:111], v[76:77], v[60:61] op_sel_hi:[0,1,1] neg_lo:[1,0,0] neg_hi:[1,0,0]
    v_pk_fma_f32 v[62:63], v[110:111], v[78:79], v[62:63] op_sel_hi:[0,1,1] neg_lo:[1,0,0] neg_hi:[1,0,0]
    v_pk_fma_f32 v[56:57], v[110:111], v[56:57], v[88:89] op_sel:[1,0,0]
    v_pk_fma_f32 v[58:59], v[110:111], v[58:59], v[90:91] op_sel:[1,0,0]
    v_pk_fma_f32 v[60:61], v[110:111], v[60:61], v[92:93] op_sel:[1,0,0]
    v_pk_fma_f32 v[62:63], v[110:111], v[62:63], v[94:95] op_sel:[1,0,0]
    v_pk_mul_f32 v[96:97], v[56:57], v[56:57]
    v_pk_mul_f32 v[98:99], v[58:59], v[58:59]
    v_pk_mul_f32 v[100:101], v[60:61], v[60:61]
    v_pk_mul_f32 v[102:103], v[62:63], v[62:63]
    v_pk_fma_f32 v[96:97], v[96:97], s[8:9], v[112:113]
    v_pk_fma_f32 v[98:99], v[98:99], s[8:9], v[112:113]
    v_pk_fma_f32 v[100:101], v[100:101], s[8:9], v[112:113]
    v_pk_fma_f32 v[102:103], v[102:103], s[8:9], v[112:113]
    v_pk_mul_f32 v[96:97], v[96:97], v[56:57]
    v_pk_mul_f32 v[98:99], v[98:99], v[58:59]
    v_pk_mul_f32 v[100:101], v[100:101], v[60:61]
    v_pk_mul_f32 v[102:103], v[102:103], v[62:63]
    v_exp_f32 v96, v96
    v_exp_f32 v97, v97
    v_exp_f32 v98, v98
    v_exp_f32 v99, v99
    v_exp_f32 v100, v100
    v_exp_f32 v101, v101
    v_exp_f32 v102, v102
    v_exp_f32 v103, v103
    v_pk_add_f32 v[96:97], v[96:97], s[10:11]
    v_pk_add_f32 v[98:99], v[98:99], s[10:11]
    v_pk_add_f32 v[100:101], v[100:101], s[10:11]
    v_pk_add_f32 v[102:103], v[102:103], s[10:11]
    v_rcp_f32 v96, v96
    v_rcp_f32 v97, v97
    v_rcp_f32 v98, v98
    v_rcp_f32 v99, v99
    v_rcp_f32 v100, v100
    v_rcp_f32 v101, v101
    v_rcp_f32 v102, v102
    v_rcp_f32 v103, v103
    v_pk_mul_f32 v[96:97], v[96:97], v[56:57]
    v_pk_mul_f32 v[98:99], v[98:99], v[58:59]
    v_pk_mul_f32 v[100:101], v[100:101], v[60:61]
    v_pk_mul_f32 v[102:103], v[102:103], v[62:63]
    v_cvt_pk_bf16_f32 v120, v96, v97
    v_cvt_pk_bf16_f32 v121, v98, v99
    v_cvt_pk_bf16_f32 v122, v100, v101
    v_cvt_pk_bf16_f32 v123, v102, v103
    buffer_store_dwordx4 v[120:123], v116, s[44:47], s5 offen offset:2560 sc1
    s_lshl_b32 s70, s63, 14
    s_add_u32 s70, s70, 114368
    v_and_b32 v97, 31, v127
    v_lshl_add_u32 v97, v97, 2, s70
    v_mov_b32 v96, 12
    ds_write_b32 v97, v96
    s_setprio 2
    s_waitcnt vmcnt(3)
    s_mov_b32 s71, 40000
L_poll_36:
    v_cmp_ne_u32 vcc, 1, v114
    s_cbranch_vccz L_ok_37
    s_sleep 4
    buffer_load_dword v114, v115, s[44:47], 0 offen offset:0 sc0 sc1
    s_sub_u32 s71, s71, 1
    s_waitcnt vmcnt(0)
    s_cbranch_scc0 L_poll_36
L_ok_37:
    s_mul_i32 s69, s72, 5120
    s_add_u32 s69, s69, s62
    buffer_load_dwordx4 a[0:3], v124, s[44:47], s69 offen offset:0 sc1
    buffer_load_dwordx4 a[4:7], v124, s[44:47], s69 offen offset:1024 sc1
    buffer_load_dwordx4 a[8:11], v124, s[44:47], s69 offen offset:2048 sc1
    buffer_load_dwordx4 a[12:15], v124, s[44:47], s69 offen offset:3072 sc1
    buffer_load_dwordx4 a[16:19], v125, s[44:47], s69 offen offset:0 sc1
    s_mul_i32 s69, s73, 5120
    s_add_u32 s69, s69, s62
    buffer_load_dwordx4 a[20:23], v124, s[44:47], s69 offen offset:0 sc1
    s_waitcnt vmcnt(6)
    v_mov_b32 v96, 1
    v_mov_b32 v97, 0
    s_mov_b64 exec, 1
    buffer_store_dword v96, v97, s[44:47], s6 offen offset:0 sc0 sc1
    s_mov_b64 exec, -1
    buffer_load_dwordx4 a[24:27], v124, s[44:47], s69 offen offset:1024 sc1
    buffer_load_dwordx4 a[28:31], v124, s[44:47], s69 offen offset:2048 sc1
    buffer_load_dwordx4 a[32:35], v124, s[44:47], s69 offen offset:3072 sc1
    buffer_load_dwordx4 a[36:39], v125, s[44:47], s69 offen offset:0 sc1
    s_mul_i32 s69, s74, 5120
    s_add_u32 s69, s69, s62
    buffer_load_dwordx4 a[40:43], v124, s[44:47], s69 offen offset:0 sc1
    buffer_load_dwordx4 a[44:47], v124, s[44:47], s69 offen offset:1024 sc1
    buffer_load_dwordx4 a[48:51], v124, s[44:47], s69 offen offset:2048 sc1
    buffer_load_dwordx4 a[52:55], v124, s[44:47], s69 offen offset:3072 sc1
    buffer_load_dwordx4 a[56:59], v125, s[44:47], s69 offen offset:0 sc1
    s_mul_i32 s69, s75, 5120
    s_add_u32 s69, s69, s62
    buffer_load_dwordx4 a[60:63], v124, s[44:47], s69 offen offset:0 sc1
    buffer_load_dwordx4 a[64:67], v124, s[44:47], s69 offen offset:1024 sc1
    buffer_load_dwordx4 a[68:71], v124, s[44:47], s69 offen offset:2048 sc1
    buffer_load_dwordx4 a[72:75], v124, s[44:47], s69 offen offset:3072 sc1
    buffer_load_dwordx4 a[76:79], v125, s[44:47], s69 offen offset:0 sc1
    s_mul_i32 s69, s76, 5120
    s_add_u32 s69, s69, s62
    buffer_load_dwordx4 a[80:83], v124, s[44:47], s69 offen offset:0 sc1
    buffer_load_dwordx4 a[84:87], v124, s[44:47], s69 offen offset:1024 sc1
    buffer_load_dwordx4 a[88:91], v124, s[44:47], s69 offen offset:2048 sc1
    buffer_load_dwordx4 a[92:95], v124, s[44:47], s69 offen offset:3072 sc1
    buffer_load_dwordx4 a[96:99], v125, s[44:47], s69 offen offset:0 sc1
    s_mul_i32 s69, s77, 5120
    s_add_u32 s69, s69, s62
    buffer_load_dwordx4 a[100:103], v124, s[44:47], s69 offen offset:0 sc1
    buffer_load_dwordx4 a[104:107], v124, s[44:47], s69 offen offset:1024 sc1
    buffer_load_dwordx4 a[108:111], v124, s[44:47], s69 offen offset:2048 sc1
    buffer_load_dwordx4 a[112:115], v124, s[44:47], s69 offen offset:3072 sc1
    buffer_load_dwordx4 a[116:119], v125, s[44:47], s69 offen offset:0 sc1
    s_add_u32 m0, s68, 16384
    s_mul_i32 s69, s78, 5120
    s_add_u32 s69, s69, s62
    buffer_load_dwordx4 v124, s[44:47], s69 offen offset:0 sc1 lds
    buffer_load_dwordx4 v124, s[44:47], s69 offen offset:1024 sc1 lds
    buffer_load_dwordx4 v124, s[44:47], s69 offen offset:2048 sc1 lds
    buffer_load_dwordx4 v124, s[44:47], s69 offen offset:3072 sc1 lds
    s_add_u32 m0, s68, 49152
    s_nop 0
    buffer_load_dwordx4 v125, s[44:47], s69 offen offset:0 sc1 lds
    s_branch L_g2
L_skipg:
    s_lshl_b32 s70, s63, 14
    s_add_u32 s70, s70, 114368
    v_and_b32 v97, 31, v127
    v_lshl_add_u32 v97, v97, 2, s70
    v_mov_b32 v96, 12
    ds_write_b32 v97, v96
L_pre2:
    s_waitcnt vmcnt(0)
    s_mov_b32 s71, 40000
L_poll_38:
    v_cmp_ne_u32 vcc, 1, v114
    s_cbranch_vccz L_ok_39
    s_sleep 16
    buffer_load_dword v114, v115, s[44:47], 0 offen offset:0 sc0 sc1
    s_sub_u32 s71, s71, 1
    s_waitcnt vmcnt(0)
    s_cbranch_scc0 L_poll_38
L_ok_39:
L_skip2:
    s_mul_i32 s69, s72, 5120
    s_add_u32 s69, s69, s62
    buffer_load_dwordx4 a[0:3], v124, s[44:47], s69 offen offset:0 sc1
    buffer_load_dwordx4 a[4:7], v124, s[44:47], s69 offen offset:1024 sc1
    buffer_load_dwordx4 a[8:11], v124, s[44:47], s69 offen offset:2048 sc1
    buffer_load_dwordx4 a[12:15], v124, s[44:47], s69 offen offset:3072 sc1
    buffer_load_dwordx4 a[16:19], v125, s[44:47], s69 offen offset:0 sc1
    s_mul_i32 s69, s73, 5120
    s_add_u32 s69, s69, s62
    buffer_load_dwordx4 a[20:23], v124, s[44:47], s69 offen offset:0 sc1
    buffer_load_dwordx4 a[24:27], v124, s[44:47], s69 offen offset:1024 sc1
    buffer_load_dwordx4 a[28:31], v124, s[44:47], s69 offen offset:2048 sc1
    buffer_load_dwordx4 a[32:35], v124, s[44:47], s69 offen offset:3072 sc1
    buffer_load_dwordx4 a[36:39], v125, s[44:47], s69 offen offset:0 sc1
    s_mul_i32 s69, s74, 5120
    s_add_u32 s69, s69, s62
    buffer_load_dwordx4 a[40:43], v124, s[44:47], s69 offen offset:0 sc1
    buffer_load_dwordx4 a[44:47], v124, s[44:47], s69 offen offset:1024 sc1
    buffer_load_dwordx4 a[48:51], v124, s[44:47], s69 offen offset:2048 sc1
    buffer_load_dwordx4 a[52:55], v124, s[44:47], s69 offen offset:3072 sc1
    buffer_load_dwordx4 a[56:59], v125, s[44:47], s69 offen offset:0 sc1
    s_mul_i32 s69, s75, 5120
    s_add_u32 s69, s69, s62
    buffer_load_dwordx4 a[60:63], v124, s[44:47], s69 offen offset:0 sc1
    buffer_load_dwordx4 a[64:67], v124, s[44:47], s69 offen offset:1024 sc1
    buffer_load_dwordx4 a[68:71], v124, s[44:47], s69 offen offset:2048 sc1
    buffer_load_dwordx4 a[72:75], v124, s[44:47], s69 offen offset:3072 sc1
    buffer_load_dwordx4 a[76:79], v125, s[44:47], s69 offen offset:0 sc1
    s_mul_i32 s69, s76, 5120
    s_add_u32 s69, s69, s62
    buffer_load_dwordx4 a[80:83], v124, s[44:47], s69 offen offset:0 sc1
    buffer_load_dwordx4 a[84:87], v124, s[44:47], s69 offen offset:1024 sc1
    buffer_load_dwordx4 a[88:91], v124, s[44:47], s69 offen offset:2048 sc1
    buffer_load_dwordx4 a[92:95], v124, s[44:47], s69 offen offset:3072 sc1
    buffer_load_dwordx4 a[96:99], v125, s[44:47], s69 offen offset:0 sc1
    s_mul_i32 s69, s77, 5120
    s_add_u32 s69, s69, s62
    buffer_load_dwordx4 a[100:103], v124, s[44:47], s69 offen offset:0 sc1
    buffer_load_dwordx4 a[104:107], v124, s[44:47], s69 offen offset:1024 sc1
    buffer_load_dwordx4 a[108:111], v124, s[44:47], s69 offen offset:2048 sc1
    buffer_load_dwordx4 a[112:115], v124, s[44:47], s69 offen offset:3072 sc1
    buffer_load_dwordx4 a[116:119], v125, s[44:47], s69 offen offset:0 sc1
    s_add_u32 m0, s68, 16384
    s_mul_i32 s69, s78, 5120
    s_add_u32 s69, s69, s62
    buffer_load_dwordx4 v124, s[44:47], s69 offen offset:0 sc1 lds
    buffer_load_dwordx4 v124, s[44:47], s69 offen offset:1024 sc1 lds
    buffer_load_dwordx4 v124, s[44:47], s69 offen offset:2048 sc1 lds
    buffer_load_dwordx4 v124, s[44:47], s69 offen offset:3072 sc1 lds
    s_add_u32 m0, s68, 49152
    s_nop 0
    buffer_load_dwordx4 v125, s[44:47], s69 offen offset:0 sc1 lds
L_g2:
    s_setprio 2
    s_lshl_b32 s66, s63, 10
    v_add_u32 v120, s66, v124
    v_xor_b32 v121, 1024, v120
    v_xor_b32 v122, 2048, v120
    v_xor_b32 v123, 3072, v120
    s_mul_i32 s66, s65, 160
    v_lshrrev_b32 v82, 4, v127
    v_lshl_add_u32 v82, v82, 3, s66
    global_load_dwordx2 v[20:21], v82, s[26:27] offset:0
    global_load_dwordx2 v[22:23], v82, s[26:27] offset:32
    global_load_dwordx2 v[24:25], v82, s[26:27] offset:64
    global_load_dwordx2 v[26:27], v82, s[26:27] offset:96
    global_load_dwordx2 v[28:29], v82, s[26:27] offset:128
    s_lshl_b32 s66, s64, 12
    s_add_u32 s66, s66, 2752512
    s_mul_i32 s67, s63, 896
    s_min_u32 s67, s67, 2560
    s_add_u32 s66, s66, s67
    v_min_u32 v81, 6, v127
    v_lshl_add_u32 v81, v81, 7, s66
    buffer_load_dword v80, v81, s[44:47], 0 offen offset:0 sc0 sc1
    s_add_u32 m0, s68, 65536
    s_mul_i32 s69, s79, 5120
    s_add_u32 s69, s69, s62
    buffer_load_dwordx4 v124, s[44:47], s69 offen offset:0 sc1 lds
    buffer_load_dwordx4 v124, s[44:47], s69 offen offset:1024 sc1 lds
    buffer_load_dwordx4 v124, s[44:47], s69 offen offset:2048 sc1 lds
    buffer_load_dwordx4 v124, s[44:47], s69 offen offset:3072 sc1 lds
    s_add_u32 m0, s68, 50176
    s_nop 0
    buffer_load_dwordx4 v125, s[44:47], s69 offen offset:0 sc1 lds
    s_add_u32 m0, s68, 32768
    s_mul_i32 s69, s80, 5120
    s_add_u32 s69, s69, s62
    buffer_load_dwordx4 v124, s[44:47], s69 offen offset:0 sc1 lds
    buffer_load_dwordx4 v124, s[44:47], s69 offen offset:1024 sc1 lds
    buffer_load_dwordx4 v124, s[44:47], s69 offen offset:2048 sc1 lds
    buffer_load_dwordx4 v124, s[44:47], s69 offen offset:3072 sc1 lds
    s_add_u32 m0, s68, 51200
    s_nop 0
    buffer_load_dwordx4 v125, s[44:47], s69 offen offset:0 sc1 lds
    s_add_u32 m0, s68, 0
    s_mul_i32 s69, s81, 5120
    s_add_u32 s69, s69, s62
    buffer_load_dwordx4 v124, s[44:47], s69 offen offset:0 sc1 lds
    buffer_load_dwordx4 v124, s[44:47], s69 offen offset:1024 sc1 lds
    buffer_load_dwordx4 v124, s[44:47], s69 offen offset:2048 sc1 lds
    buffer_load_dwordx4 v124, s[44:47], s69 offen offset:3072 sc1 lds
    s_add_u32 m0, s68, 52224
    s_nop 0
    buffer_load_dwordx4 v125, s[44:47], s69 offen offset:0 sc1 lds
    s_waitcnt vmcnt(15)
    s_mov_b32 s71, 40000
L_poll_40:
    v_cmp_ne_u32 vcc, 1, v80
    s_cbranch_vccz L_ok_41
    s_sleep 4
    buffer_load_dword v80, v81, s[44:47], 0 offen offset:0 sc0 sc1
    s_sub_u32 s71, s71, 1
    s_waitcnt vmcnt(0)
    s_cbranch_scc0 L_poll_40
L_ok_41:
    s_lshl_b32 s70, s72, 12
    s_add_u32 s70, s70, s61
    buffer_load_dwordx4 v[84:87], v121, s[44:47], s70 offen sc1
    buffer_load_dwordx4 v[88:91], v122, s[44:47], s70 offen sc1
    buffer_load_dwordx4 v[92:95], v123, s[44:47], s70 offen sc1
    buffer_load_dwordx4 v[80:83], v120, s[44:47], s70 offen sc1
    s_lshl_b32 s70, s73, 12
    s_add_u32 s70, s70, s61
    buffer_load_dwordx4 v[100:103], v121, s[44:47], s70 offen sc1
    buffer_load_dwordx4 v[104:107], v122, s[44:47], s70 offen sc1
    buffer_load_dwordx4 v[108:111], v123, s[44:47], s70 offen sc1
    buffer_load_dwordx4 v[96:99], v120, s[44:47], s70 offen sc1
    s_lshl_b32 s70, s74, 12
    s_add_u32 s70, s70, s61
    buffer_load_dwordx4 v[116:119], v121, s[44:47], s70 offen sc1
    buffer_load_dwordx4 a[120:123], v122, s[44:47], s70 offen sc1
    buffer_load_dwordx4 a[124:127], v123, s[44:47], s70 offen sc1
    buffer_load_dwordx4 v[112:115], v120, s[44:47], s70 offen sc1
    v_lshlrev_b32 v0, 16, v20
    v_and_b32 v1, 0xffff0000, v20
    v_lshlrev_b32 v2, 16, v21
    v_and_b32 v3, 0xffff0000, v21
    v_lshlrev_b32 v4, 16, v22
    v_and_b32 v5, 0xffff0000, v22
    v_lshlrev_b32 v6, 16, v23
    v_and_b32 v7, 0xffff0000, v23
    v_lshlrev_b32 v8, 16, v24
    v_and_b32 v9, 0xffff0000, v24
    v_lshlrev_b32 v10, 16, v25
    v_and_b32 v11, 0xffff0000, v25
    v_lshlrev_b32 v12, 16, v26
    v_and_b32 v13, 0xffff0000, v26
    v_lshlrev_b32 v14, 16, v27
    v_and_b32 v15, 0xffff0000, v27
    v_lshlrev_b32 v16, 16, v28
    v_and_b32 v17, 0xffff0000, v28
    v_lshlrev_b32 v18, 16, v29
    v_and_b32 v19, 0xffff0000, v29
    s_waitcnt vmcnt(11)
    v_mfma_f32_16x16x32_bf16 v[20:23], a[0:3], v[84:87], 0
    v_mfma_f32_16x16x32_bf16 v[24:27], a[4:7], v[84:87], 0
    v_mfma_f32_16x16x32_bf16 v[28:31], a[8:11], v[84:87], 0
    v_mfma_f32_16x16x32_bf16 v[32:35], a[12:15], v[84:87], 0
    v_mfma_f32_16x16x32_bf16 v[36:39], a[16:19], v[84:87], 0
    s_lshl_b32 s70, s75, 12
    s_add_u32 s70, s70, s61
    buffer_load_dwordx4 v[84:87], v121, s[44:47], s70 offen sc1
    s_waitcnt vmcnt(11)
    v_mfma_f32_16x16x32_bf16 v[40:43], a[0:3], v[88:91], 0
    v_mfma_f32_16x16x32_bf16 v[44:47], a[4:7], v[88:91], 0
    v_mfma_f32_16x16x32_bf16 v[48:51], a[8:11], v[88:91], 0
    v_mfma_f32_16x16x32_bf16 v[52:55], a[12:15], v[88:91], 0
    v_mfma_f32_16x16x32_bf16 v[56:59], a[16:19], v[88:91], 0
    buffer_load_dwordx4 v[88:91], v122, s[44:47], s70 offen sc1
    s_waitcnt vmcnt(11)
    v_mfma_f32_16x16x32_bf16 v[60:63], a[0:3], v[92:95], 0
    v_mfma_f32_16x16x32_bf16 v[64:67], a[4:7], v[92:95], 0
    v_mfma_f32_16x16x32_bf16 v[68:71], a[8:11], v[92:95], 0
    v_mfma_f32_16x16x32_bf16 v[72:75], a[12:15], v[92:95], 0
    v_mfma_f32_16x16x32_bf16 v[76:79], a[16:19], v[92:95], 0
    buffer_load_dwordx4 v[92:95], v123, s[44:47], s70 offen sc1
    s_waitcnt vmcnt(11)
    v_mfma_f32_16x16x32_bf16 v[0:3], a[0:3], v[80:83], v[0:3]
    v_mfma_f32_16x16x32_bf16 v[4:7], a[4:7], v[80:83], v[4:7]
    v_mfma_f32_16x16x32_bf16 v[8:11], a[8:11], v[80:83], v[8:11]
    v_mfma_f32_16x16x32_bf16 v[12:15], a[12:15], v[80:83], v[12:15]
    v_mfma_f32_16x16x32_bf16 v[16:19], a[16:19], v[80:83], v[16:19]
    buffer_load_dwordx4 v[80:83], v120, s[44:47], s70 offen sc1
    s_waitcnt vmcnt(11)
    v_mfma_f32_16x16x32_bf16 v[20:23], a[20:23], v[100:103], v[20:23]
    v_mfma_f32_16x16x32_bf16 v[24:27], a[24:27], v[100:103], v[24:27]
    v_mfma_f32_16x16x32_bf16 v[28:31], a[28:31], v[100:103], v[28:31]
    v_mfma_f32_16x16x32_bf16 v[32:35], a[32:35], v[100:103], v[32:35]
    v_mfma_f32_16x16x32_bf16 v[36:39], a[36:39], v[100:103], v[36:39]
    s_lshl_b32 s70, s76, 12
    s_add_u32 s70, s70, s61
    buffer_load_dwordx4 v[100:103], v121, s[44:47], s70 offen sc1
    s_waitcnt vmcnt(11)
    v_mfma_f32_16x16x32_bf16 v[40:43], a[20:23], v[104:107], v[40:43]
    v_mfma_f32_16x16x32_bf16 v[44:47], a[24:27], v[104:107], v[44:47]
    v_mfma_f32_16x16x32_bf16 v[48:51], a[28:31], v[104:107], v[48:51]
    v_mfma_f32_16x16x32_bf16 v[52:55], a[32:35], v[104:107], v[52:55]
    v_mfma_f32_16x16x32_bf16 v[56:59], a[36:39], v[104:107], v[56:59]
    buffer_load_dwordx4 v[104:107], v122, s[44:47], s70 offen sc1
    s_waitcnt vmcnt(11)
    v_mfma_f32_16x16x32_bf16 v[60:63], a[20:23], v[108:111], v[60:63]
    v_mfma_f32_16x16x32_bf16 v[64:67], a[24:27], v[108:111], v[64:67]
    v_mfma_f32_16x16x32_bf16 v[68:71], a[28:31], v[108:111], v[68:71]
    v_mfma_f32_16x16x32_bf16 v[72:75], a[32:35], v[108:111], v[72:75]
    v_mfma_f32_16x16x32_bf16 v[76:79], a[36:39], v[108:111], v[76:79]
    buffer_load_dwordx4 v[108:111], v123, s[44:47], s70 offen sc1
    s_waitcnt vmcnt(11)
    v_mfma_f32_16x16x32_bf16 v[0:3], a[20:23], v[96:99], v[0:3]
    v_mfma_f32_16x16x32_bf16 v[4:7], a[24:27], v[96:99], v[4:7]
    v_mfma_f32_16x16x32_bf16 v[8:11], a[28:31], v[96:99], v[8:11]
    v_mfma_f32_16x16x32_bf16 v[12:15], a[32:35], v[96:99], v[12:15]
    v_mfma_f32_16x16x32_bf16 v[16:19], a[36:39], v[96:99], v[16:19]
    buffer_load_dwordx4 v[96:99], v120, s[44:47], s70 offen sc1
    s_waitcnt vmcnt(11)
    v_mfma_f32_16x16x32_bf16 v[20:23], a[40:43], v[116:119], v[20:23]
    v_mfma_f32_16x16x32_bf16 v[24:27], a[44:47], v[116:119], v[24:27]
    v_mfma_f32_16x16x32_bf16 v[28:31], a[48:51], v[116:119], v[28:31]
    v_mfma_f32_16x16x32_bf16 v[32:35], a[52:55], v[116:119], v[32:35]
    v_mfma_f32_16x16x32_bf16 v[36:39], a[56:59], v[116:119], v[36:39]
    s_lshl_b32 s70, s77, 12
    s_add_u32 s70, s70, s61
    buffer_load_dwordx4 v[116:119], v121, s[44:47], s70 offen sc1
    s_waitcnt vmcnt(11)
    v_mfma_f32_16x16x32_bf16 v[40:43], a[40:43], a[120:123], v[40:43]
    v_mfma_f32_16x16x32_bf16 v[44:47], a[44:47], a[120:123], v[44:47]
    v_mfma_f32_16x16x32_bf16 v[48:51], a[48:51], a[120:123], v[48:51]
    v_mfma_f32_16x16x32_bf16 v[52:55], a[52:55], a[120:123], v[52:55]
    v_mfma_f32_16x16x32_bf16 v[56:59], a[56:59], a[120:123], v[56:59]
    buffer_load_dwordx4 a[120:123], v122, s[44:47], s70 offen sc1
    s_waitcnt vmcnt(11)
    v_mfma_f32_16x16x32_bf16 v[60:63], a[40:43], a[124:127], v[60:63]
    v_mfma_f32_16x16x32_bf16 v[64:67], a[44:47], a[124:127], v[64:67]
    v_mfma_f32_16x16x32_bf16 v[68:71], a[48:51], a[124:127], v[68:71]
    v_mfma_f32_16x16x32_bf16 v[72:75], a[52:55], a[124:127], v[72:75]
    v_mfma_f32_16x16x32_bf16 v[76:79], a[56:59], a[124:127], v[76:79]
    buffer_load_dwordx4 a[124:127], v123, s[44:47], s70 offen sc1
    s_waitcnt vmcnt(11)
    v_mfma_f32_16x16x32_bf16 v[0:3], a[40:43], v[112:115], v[0:3]
    v_mfma_f32_16x16x32_bf16 v[4:7], a[44:47], v[112:115], v[4:7]
    v_mfma_f32_16x16x32_bf16 v[8:11], a[48:51], v[112:115], v[8:11]
    v_mfma_f32_16x16x32_bf16 v[12:15], a[52:55], v[112:115], v[12:15]
    v_mfma_f32_16x16x32_bf16 v[16:19], a[56:59], v[112:115], v[16:19]
    buffer_load_dwordx4 v[112:115], v120, s[44:47], s70 offen sc1
    s_waitcnt vmcnt(11)
    v_mfma_f32_16x16x32_bf16 v[20:23], a[60:63], v[84:87], v[20:23]
    v_mfma_f32_16x16x32_bf16 v[24:27], a[64:67], v[84:87], v[24:27]
    s_mul_i32 s69, s82, 5120
    s_add_u32 s69, s69, s62
    buffer_load_dwordx4 a[0:3], v124, s[44:47], s69 offen offset:0 sc1
    v_mfma_f32_16x16x32_bf16 v[28:31], a[68:71], v[84:87], v[28:31]
    v_mfma_f32_16x16x32_bf16 v[32:35], a[72:75], v[84:87], v[32:35]
    v_mfma_f32_16x16x32_bf16 v[36:39], a[76:79], v[84:87], v[36:39]
    s_lshl_b32 s70, s78, 12
    s_add_u32 s70, s70, s61
    buffer_load_dwordx4 v[84:87], v121, s[44:47], s70 offen sc1
    buffer_load_dwordx4 a[4:7], v124, s[44:47], s69 offen offset:1024 sc1
    s_waitcnt vmcnt(13)
    v_mfma_f32_16x16x32_bf16 v[40:43], a[60:63], v[88:91], v[40:43]
    v_mfma_f32_16x16x32_bf16 v[44:47], a[64:67], v[88:91], v[44:47]
    v_mfma_f32_16x16x32_bf16 v[48:51], a[68:71], v[88:91], v[48:51]
    v_mfma_f32_16x16x32_bf16 v[52:55], a[72:75], v[88:91], v[52:55]
    buffer_load_dwordx4 a[8:11], v124, s[44:47], s69 offen offset:2048 sc1
    v_mfma_f32_16x16x32_bf16 v[56:59], a[76:79], v[88:91], v[56:59]
    buffer_load_dwordx4 v[88:91], v122, s[44:47], s70 offen sc1
    s_waitcnt vmcnt(14)
    v_mfma_f32_16x16x32_bf16 v[60:63], a[60:63], v[92:95], v[60:63]
    v_mfma_f32_16x16x32_bf16 v[64:67], a[64:67], v[92:95], v[64:67]
    buffer_load_dwordx4 a[12:15], v124, s[44:47], s69 offen offset:3072 sc1
    v_mfma_f32_16x16x32_bf16 v[68:71], a[68:71], v[92:95], v[68:71]
    v_mfma_f32_16x16x32_bf16 v[72:75], a[72:75], v[92:95], v[72:75]
    v_mfma_f32_16x16x32_bf16 v[76:79], a[76:79], v[92:95], v[76:79]
    buffer_load_dwordx4 v[92:95], v123, s[44:47], s70 offen sc1
    s_waitcnt vmcnt(15)
    v_mfma_f32_16x16x32_bf16 v[0:3], a[60:63], v[80:83], v[0:3]
    buffer_load_dwordx4 a[16:19], v125, s[44:47], s69 offen offset:0 sc1
    v_mfma_f32_16x16x32_bf16 v[4:7], a[64:67], v[80:83], v[4:7]
    v_mfma_f32_16x16x32_bf16 v[8:11], a[68:71], v[80:83], v[8:11]
    v_mfma_f32_16x16x32_bf16 v[12:15], a[72:75], v[80:83], v[12:15]
    v_mfma_f32_16x16x32_bf16 v[16:19], a[76:79], v[80:83], v[16:19]
    buffer_load_dwordx4 v[80:83], v120, s[44:47], s70 offen sc1
    s_waitcnt vmcnt(16)
    v_mfma_f32_16x16x32_bf16 v[20:23], a[80:83], v[100:103], v[20:23]
    v_mfma_f32_16x16x32_bf16 v[24:27], a[84:87], v[100:103], v[24:27]
    v_mfma_f32_16x16x32_bf16 v[28:31], a[88:91], v[100:103], v[28:31]
    v_mfma_f32_16x16x32_bf16 v[32:35], a[92:95], v[100:103], v[32:35]
    v_mfma_f32_16x16x32_bf16 v[36:39], a[96:99], v[100:103], v[36:39]
    s_lshl_b32 s70, s79, 12
    s_add_u32 s70, s70, s61
    buffer_load_dwordx4 v[100:103], v121, s[44:47], s70 offen sc1
    s_waitcnt vmcnt(16)
    v_mfma_f32_16x16x32_bf16 v[40:43], a[80:83], v[104:107], v[40:43]
    v_mfma_f32_16x16x32_bf16 v[44:47], a[84:87], v[104:107], v[44:47]
    v_mfma_f32_16x16x32_bf16 v[48:51], a[88:91], v[104:107], v[48:51]
    v_mfma_f32_16x16x32_bf16 v[52:55], a[92:95], v[104:107], v[52:55]
    v_mfma_f32_16x16x32_bf16 v[56:59], a[96:99], v[104:107], v[56:59]
    buffer_load_dwordx4 v[104:107], v122, s[44:47], s70 offen sc1
    s_waitcnt vmcnt(16)
    v_mfma_f32_16x16x32_bf16 v[60:63], a[80:83], v[108:111], v[60:63]
    v_mfma_f32_16x16x32_bf16 v[64:67], a[84:87], v[108:111], v[64:67]
    v_mfma_f32_16x16x32_bf16 v[68:71], a[88:91], v[108:111], v[68:71]
    v_mfma_f32_16x16x32_bf16 v[72:75], a[92:95], v[108:111], v[72:75]
    v_mfma_f32_16x16x32_bf16 v[76:79], a[96:99], v[108:111], v[76:79]
    buffer_load_dwordx4 v[108:111], v123, s[44:47], s70 offen sc1
    s_waitcnt vmcnt(16)
    v_mfma_f32_16x16x32_bf16 v[0:3], a[80:83], v[96:99], v[0:3]
    v_mfma_f32_16x16x32_bf16 v[4:7], a[84:87], v[96:99], v[4:7]
    v_mfma_f32_16x16x32_bf16 v[8:11], a[88:91], v[96:99], v[8:11]
    v_mfma_f32_16x16x32_bf16 v[12:15], a[92:95], v[96:99], v[12:15]
    v_mfma_f32_16x16x32_bf16 v[16:19], a[96:99], v[96:99], v[16:19]
    buffer_load_dwordx4 v[96:99], v120, s[44:47], s70 offen sc1
    s_waitcnt vmcnt(16)
    v_mfma_f32_16x16x32_bf16 v[20:23], a[100:103], v[116:119], v[20:23]
    v_mfma_f32_16x16x32_bf16 v[24:27], a[104:107], v[116:119], v[24:27]
    s_mul_i32 s69, s83, 5120
    s_add_u32 s69, s69, s62
    buffer_load_dwordx4 a[20:23], v124, s[44:47], s69 offen offset:0 sc1
    v_mfma_f32_16x16x32_bf16 v[28:31], a[108:111], v[116:119], v[28:31]
    buffer_load_dwordx4 a[24:27], v124, s[44:47], s69 offen offset:1024 sc1
    v_mfma_f32_16x16x32_bf16 v[32:35], a[112:115], v[116:119], v[32:35]
    v_mfma_f32_16x16x32_bf16 v[36:39], a[116:119], v[116:119], v[36:39]
    s_lshl_b32 s70, s80, 12
    s_add_u32 s70, s70, s61
    buffer_load_dwordx4 v[116:119], v121, s[44:47], s70 offen sc1
    buffer_load_dwordx4 a[28:31], v124, s[44:47], s69 offen offset:2048 sc1
    s_waitcnt vmcnt(19)
    v_mfma_f32_16x16x32_bf16 v[40:43], a[100:103], a[120:123], v[40:43]
    v_mfma_f32_16x16x32_bf16 v[44:47], a[104:107], a[120:123], v[44:47]
    buffer_load_dwordx4 a[32:35], v124, s[44:47], s69 offen offset:3072 sc1
    v_mfma_f32_16x16x32_bf16 v[48:51], a[108:111], a[120:123], v[48:51]
    v_mfma_f32_16x16x32_bf16 v[52:55], a[112:115], a[120:123], v[52:55]
    buffer_load_dwordx4 a[36:39], v125, s[44:47], s69 offen offset:0 sc1
    v_mfma_f32_16x16x32_bf16 v[56:59], a[116:119], a[120:123], v[56:59]
    buffer_load_dwordx4 a[120:123], v122, s[44:47], s70 offen sc1
    s_waitcnt vmcnt(21)
    v_mfma_f32_16x16x32_bf16 v[60:63], a[100:103], a[124:127], v[60:63]
    ds_read_b128 a[40:43], v126 offset:0
    v_mfma_f32_16x16x32_bf16 v[64:67], a[104:107], a[124:127], v[64:67]
    ds_read_b128 a[44:47], v126 offset:1024
    v_mfma_f32_16x16x32_bf16 v[68:71], a[108:111], a[124:127], v[68:71]
    v_mfma_f32_16x16x32_bf16 v[72:75], a[112:115], a[124:127], v[72:75]
    ds_read_b128 a[48:51], v126 offset:2048
    v_mfma_f32_16x16x32_bf16 v[76:79], a[116:119], a[124:127], v[76:79]
    buffer_load_dwordx4 a[124:127], v123, s[44:47], s70 offen sc1
    s_waitcnt vmcnt(21)
    v_mfma_f32_16x16x32_bf16 v[0:3], a[100:103], v[112:115], v[0:3]
    ds_read_b128 a[52:55], v126 offset:3072
    v_mfma_f32_16x16x32_bf16 v[4:7], a[104:107], v[112:115], v[4:7]
    v_mfma_f32_16x16x32_bf16 v[8:11], a[108:111], v[112:115], v[8:11]
    ds_read_b128 a[56:59], v126 offset:32768
    v_mfma_f32_16x16x32_bf16 v[12:15], a[112:115], v[112:115], v[12:15]
    v_mfma_f32_16x16x32_bf16 v[16:19], a[116:119], v[112:115], v[16:19]
    buffer_load_dwordx4 v[112:115], v120, s[44:47], s70 offen sc1
    s_waitcnt vmcnt(20)
    s_waitcnt lgkmcnt(0)
    v_mfma_f32_16x16x32_bf16 v[20:23], a[40:43], v[84:87], v[20:23]
    v_mfma_f32_16x16x32_bf16 v[24:27], a[44:47], v[84:87], v[24:27]
    ds_read_b128 a[60:63], v126 offset:49152
    v_mfma_f32_16x16x32_bf16 v[28:31], a[48:51], v[84:87], v[28:31]
    v_mfma_f32_16x16x32_bf16 v[32:35], a[52:55], v[84:87], v[32:35]
    v_mfma_f32_16x16x32_bf16 v[36:39], a[56:59], v[84:87], v[36:39]
    s_lshl_b32 s70, s81, 12
    s_add_u32 s70, s70, s61
    buffer_load_dwordx4 v[84:87], v121, s[44:47], s70 offen sc1
    ds_read_b128 a[64:67], v126 offset:50176
    s_waitcnt vmcnt(18)
    v_mfma_f32_16x16x32_bf16 v[40:43], a[40:43], v[88:91], v[40:43]
    v_mfma_f32_16x16x32_bf16 v[44:47], a[44:47], v[88:91], v[44:47]
    v_mfma_f32_16x16x32_bf16 v[48:51], a[48:51], v[88:91], v[48:51]
    v_mfma_f32_16x16x32_bf16 v[52:55], a[52:55], v[88:91], v[52:55]
    ds_read_b128 a[68:71], v126 offset:51200
    v_mfma_f32_16x16x32_bf16 v[56:59], a[56:59], v[88:91], v[56:59]
    buffer_load_dwordx4 v[88:91], v122, s[44:47], s70 offen sc1
    s_waitcnt vmcnt(17)
    v_mfma_f32_16x16x32_bf16 v[60:63], a[40:43], v[92:95], v[60:63]
    v_mfma_f32_16x16x32_bf16 v[64:67], a[44:47], v[92:95], v[64:67]
    ds_read_b128 a[72:75], v126 offset:52224
    v_mfma_f32_16x16x32_bf16 v[68:71], a[48:51], v[92:95], v[68:71]
    v_mfma_f32_16x16x32_bf16 v[72:75], a[52:55], v[92:95], v[72:75]
    v_mfma_f32_16x16x32_bf16 v[76:79], a[56:59], v[92:95], v[76:79]
    buffer_load_dwordx4 v[92:95], v123, s[44:47], s70 offen sc1
    s_waitcnt vmcnt(16)
    v_mfma_f32_16x16x32_bf16 v[0:3], a[40:43], v[80:83], v[0:3]
    ds_read_b128 a[76:79], v126 offset:33792
    v_mfma_f32_16x16x32_bf16 v[4:7], a[44:47], v[80:83], v[4:7]
    v_mfma_f32_16x16x32_bf16 v[8:11], a[48:51], v[80:83], v[8:11]
    v_mfma_f32_16x16x32_bf16 v[12:15], a[52:55], v[80:83], v[12:15]
    v_mfma_f32_16x16x32_bf16 v[16:19], a[56:59], v[80:83], v[16:19]
    buffer_load_dwordx4 v[80:83], v120, s[44:47], s70 offen sc1
    s_waitcnt vmcnt(16)
    s_waitcnt lgkmcnt(0)
    v_mfma_f32_16x16x32_bf16 v[20:23], a[60:63], v[100:103], v[20:23]
    v_mfma_f32_16x16x32_bf16 v[24:27], a[64:67], v[100:103], v[24:27]
    s_mul_i32 s69, s84, 5120
    s_add_u32 s69, s69, s62
    buffer_load_dwordx4 a[80:83], v124, s[44:47], s69 offen offset:0 sc1
    v_mfma_f32_16x16x32_bf16 v[28:31], a[68:71], v[100:103], v[28:31]
    buffer_load_dwordx4 a[84:87], v124, s[44:47], s69 offen offset:1024 sc1
    v_mfma_f32_16x16x32_bf16 v[32:35], a[72:75], v[100:103], v[32:35]
    v_mfma_f32_16x16x32_bf16 v[36:39], a[76:79], v[100:103], v[36:39]
    s_lshl_b32 s70, s82, 12
    s_add_u32 s70, s70, s61
    buffer_load_dwordx4 v[100:103], v121, s[44:47], s70 offen sc1
    buffer_load_dwordx4 a[88:91], v124, s[44:47], s69 offen offset:2048 sc1
    s_waitcnt vmcnt(19)
    v_mfma_f32_16x16x32_bf16 v[40:43], a[60:63], v[104:107], v[40:43]
    v_mfma_f32_16x16x32_bf16 v[44:47], a[64:67], v[104:107], v[44:47]
    buffer_load_dwordx4 a[92:95], v124, s[44:47], s69 offen offset:3072 sc1
    v_mfma_f32_16x16x32_bf16 v[48:51], a[68:71], v[104:107], v[48:51]
    v_mfma_f32_16x16x32_bf16 v[52:55], a[72:75], v[104:107], v[52:55]
    buffer_load_dwordx4 a[96:99], v125, s[44:47], s69 offen offset:0 sc1
    v_mfma_f32_16x16x32_bf16 v[56:59], a[76:79], v[104:107], v[56:59]
    buffer_load_dwordx4 v[104:107], v122, s[44:47], s70 offen sc1
    s_waitcnt vmcnt(21)
    v_mfma_f32_16x16x32_bf16 v[60:63], a[60:63], v[108:111], v[60:63]
    ds_read_b128 a[40:43], v126 offset:16384
    v_mfma_f32_16x16x32_bf16 v[64:67], a[64:67], v[108:111], v[64:67]
    ds_read_b128 a[44:47], v126 offset:17408
    v_mfma_f32_16x16x32_bf16 v[68:71], a[68:71], v[108:111], v[68:71]
    v_mfma_f32_16x16x32_bf16 v[72:75], a[72:75], v[108:111], v[72:75]
    ds_read_b128 a[48:51], v126 offset:18432
    v_mfma_f32_16x16x32_bf16 v[76:79], a[76:79], v[108:111], v[76:79]
    buffer_load_dwordx4 v[108:111], v123, s[44:47], s70 offen sc1
    s_waitcnt vmcnt(21)
    v_mfma_f32_16x16x32_bf16 v[0:3], a[60:63], v[96:99], v[0:3]
    ds_read_b128 a[52:55], v126 offset:19456
    v_mfma_f32_16x16x32_bf16 v[4:7], a[64:67], v[96:99], v[4:7]
    v_mfma_f32_16x16x32_bf16 v[8:11], a[68:71], v[96:99], v[8:11]
    ds_read_b128 a[56:59], v126 offset:34816
    v_mfma_f32_16x16x32_bf16 v[12:15], a[72:75], v[96:99], v[12:15]
    v_mfma_f32_16x16x32_bf16 v[16:19], a[76:79], v[96:99], v[16:19]
    buffer_load_dwordx4 v[96:99], v120, s[44:47], s70 offen sc1
    v_add_u32 v126, -16384, v126
    s_waitcnt vmcnt(19)
    s_waitcnt lgkmcnt(0)
    v_mfma_f32_16x16x32_bf16 v[20:23], a[40:43], v[116:119], v[20:23]
    v_mfma_f32_16x16x32_bf16 v[24:27], a[44:47], v[116:119], v[24:27]
    ds_read_b128 a[60:63], v126 offset:0
    v_mfma_f32_16x16x32_bf16 v[28:31], a[48:51], v[116:119], v[28:31]
    v_mfma_f32_16x16x32_bf16 v[32:35], a[52:55], v[116:119], v[32:35]
    v_mfma_f32_16x16x32_bf16 v[36:39], a[56:59], v[116:119], v[36:39]
    s_lshl_b32 s70, s83, 12
    s_add_u32 s70, s70, s61
    buffer_load_dwordx4 v[116:119], v121, s[44:47], s70 offen sc1
    ds_read_b128 a[64:67], v126 offset:1024
    s_waitcnt vmcnt(16)
    v_mfma_f32_16x16x32_bf16 v[40:43], a[40:43], a[120:123], v[40:43]
    v_mfma_f32_16x16x32_bf16 v[44:47], a[44:47], a[120:123], v[44:47]
    v_mfma_f32_16x16x32_bf16 v[48:51], a[48:51], a[120:123], v[48:51]
    v_mfma_f32_16x16x32_bf16 v[52:55], a[52:55], a[120:123], v[52:55]
    ds_read_b128 a[68:71], v126 offset:2048
    v_mfma_f32_16x16x32_bf16 v[56:59], a[56:59], a[120:123], v[56:59]
    buffer_load_dwordx4 a[120:123], v122, s[44:47], s70 offen sc1
    s_waitcnt vmcnt(16)
    v_mfma_f32_16x16x32_bf16 v[60:63], a[40:43], a[124:127], v[60:63]
    v_mfma_f32_16x16x32_bf16 v[64:67], a[44:47], a[124:127], v[64:67]
    ds_read_b128 a[72:75], v126 offset:3072
    v_mfma_f32_16x16x32_bf16 v[68:71], a[48:51], a[124:127], v[68:71]
    v_mfma_f32_16x16x32_bf16 v[72:75], a[52:55], a[124:127], v[72:75]
    v_mfma_f32_16x16x32_bf16 v[76:79], a[56:59], a[124:127], v[76:79]
    buffer_load_dwordx4 a[124:127], v123, s[44:47], s70 offen sc1
    s_waitcnt vmcnt(16)
    v_mfma_f32_16x16x32_bf16 v[0:3], a[40:43], v[112:115], v[0:3]
    ds_read_b128 a[76:79], v126 offset:52224
    v_mfma_f32_16x16x32_bf16 v[4:7], a[44:47], v[112:115], v[4:7]
    v_mfma_f32_16x16x32_bf16 v[8:11], a[48:51], v[112:115], v[8:11]
    v_mfma_f32_16x16x32_bf16 v[12:15], a[52:55], v[112:115], v[12:15]
    v_mfma_f32_16x16x32_bf16 v[16:19], a[56:59], v[112:115], v[16:19]
    buffer_load_dwordx4 v[112:115], v120, s[44:47], s70 offen sc1
    s_lshl_b32 s14, s65, 2
    s_add_u32 s14, s14, s63
    s_mul_i32 s66, s14, 2560
    s_add_u32 s66, s66, 2883584
    v_min_u32 v126, 19, v127
    v_lshl_add_u32 v126, v126, 7, s66
    buffer_load_dword v126, v126, s[44:47], 0 offen offset:0 sc0 sc1
    s_waitcnt vmcnt(17)
    s_waitcnt lgkmcnt(0)
    v_mfma_f32_16x16x32_bf16 v[20:23], a[60:63], v[84:87], v[20:23]
    v_mfma_f32_16x16x32_bf16 v[24:27], a[64:67], v[84:87], v[24:27]
    s_mul_i32 s69, s85, 5120
    s_add_u32 s69, s69, s62
    buffer_load_dwordx4 a[100:103], v124, s[44:47], s69 offen offset:0 sc1
    v_mfma_f32_16x16x32_bf16 v[28:31], a[68:71], v[84:87], v[28:31]
    v_mfma_f32_16x16x32_bf16 v[32:35], a[72:75], v[84:87], v[32:35]
    v_mfma_f32_16x16x32_bf16 v[36:39], a[76:79], v[84:87], v[36:39]
    s_lshl_b32 s70, s84, 12
    s_add_u32 s70, s70, s61
    buffer_load_dwordx4 v[84:87], v121, s[44:47], s70 offen sc1
    buffer_load_dwordx4 a[104:107], v124, s[44:47], s69 offen offset:1024 sc1
    s_waitcnt vmcnt(19)
    v_mfma_f32_16x16x32_bf16 v[40:43], a[60:63], v[88:91], v[40:43]
    v_mfma_f32_16x16x32_bf16 v[44:47], a[64:67], v[88:91], v[44:47]
    v_mfma_f32_16x16x32_bf16 v[48:51], a[68:71], v[88:91], v[48:51]
    v_mfma_f32_16x16x32_bf16 v[52:55], a[72:75], v[88:91], v[52:55]
    buffer_load_dwordx4 a[108:111], v124, s[44:47], s69 offen offset:2048 sc1
    v_mfma_f32_16x16x32_bf16 v[56:59], a[76:79], v[88:91], v[56:59]
    buffer_load_dwordx4 v[88:91], v122, s[44:47], s70 offen sc1
    s_waitcnt vmcnt(20)
    v_mfma_f32_16x16x32_bf16 v[60:63], a[60:63], v[92:95], v[60:63]
    v_mfma_f32_16x16x32_bf16 v[64:67], a[64:67], v[92:95], v[64:67]
    buffer_load_dwordx4 a[112:115], v124, s[44:47], s69 offen offset:3072 sc1
    v_mfma_f32_16x16x32_bf16 v[68:71], a[68:71], v[92:95], v[68:71]
    v_mfma_f32_16x16x32_bf16 v[72:75], a[72:75], v[92:95], v[72:75]
    v_mfma_f32_16x16x32_bf16 v[76:79], a[76:79], v[92:95], v[76:79]
    buffer_load_dwordx4 v[92:95], v123, s[44:47], s70 offen sc1
    s_waitcnt vmcnt(21)
    v_mfma_f32_16x16x32_bf16 v[0:3], a[60:63], v[80:83], v[0:3]
    buffer_load_dwordx4 a[116:119], v125, s[44:47], s69 offen offset:0 sc1
    v_mfma_f32_16x16x32_bf16 v[4:7], a[64:67], v[80:83], v[4:7]
    v_mfma_f32_16x16x32_bf16 v[8:11], a[68:71], v[80:83], v[8:11]
    v_mfma_f32_16x16x32_bf16 v[12:15], a[72:75], v[80:83], v[12:15]
    v_mfma_f32_16x16x32_bf16 v[16:19], a[76:79], v[80:83], v[16:19]
    buffer_load_dwordx4 v[80:83], v120, s[44:47], s70 offen sc1
    s_waitcnt vmcnt(20)
    v_mfma_f32_16x16x32_bf16 v[20:23], a[0:3], v[100:103], v[20:23]
    v_mfma_f32_16x16x32_bf16 v[24:27], a[4:7], v[100:103], v[24:27]
    v_mfma_f32_16x16x32_bf16 v[28:31], a[8:11], v[100:103], v[28:31]
    v_mfma_f32_16x16x32_bf16 v[32:35], a[12:15], v[100:103], v[32:35]
    v_mfma_f32_16x16x32_bf16 v[36:39], a[16:19], v[100:103], v[36:39]
    s_lshl_b32 s70, s85, 12
    s_add_u32 s70, s70, s61
    buffer_load_dwordx4 v[100:103], v121, s[44:47], s70 offen sc1
    s_waitcnt vmcnt(17)
    v_mfma_f32_16x16x32_bf16 v[40:43], a[0:3], v[104:107], v[40:43]
    v_mfma_f32_16x16x32_bf16 v[44:47], a[4:7], v[104:107], v[44:47]
    v_mfma_f32_16x16x32_bf16 v[48:51], a[8:11], v[104:107], v[48:51]
    v_mfma_f32_16x16x32_bf16 v[52:55], a[12:15], v[104:107], v[52:55]
    v_mfma_f32_16x16x32_bf16 v[56:59], a[16:19], v[104:107], v[56:59]
    buffer_load_dwordx4 v[104:107], v122, s[44:47], s70 offen sc1
    s_waitcnt vmcnt(17)
    v_mfma_f32_16x16x32_bf16 v[60:63], a[0:3], v[108:111], v[60:63]
    v_mfma_f32_16x16x32_bf16 v[64:67], a[4:7], v[108:111], v[64:67]
    v_mfma_f32_16x16x32_bf16 v[68:71], a[8:11], v[108:111], v[68:71]
    v_mfma_f32_16x16x32_bf16 v[72:75], a[12:15], v[108:111], v[72:75]
    v_mfma_f32_16x16x32_bf16 v[76:79], a[16:19], v[108:111], v[76:79]
    buffer_load_dwordx4 v[108:111], v123, s[44:47], s70 offen sc1
    s_waitcnt vmcnt(17)
    v_mfma_f32_16x16x32_bf16 v[0:3], a[0:3], v[96:99], v[0:3]
    v_mfma_f32_16x16x32_bf16 v[4:7], a[4:7], v[96:99], v[4:7]
    v_mfma_f32_16x16x32_bf16 v[8:11], a[8:11], v[96:99], v[8:11]
    v_mfma_f32_16x16x32_bf16 v[12:15], a[12:15], v[96:99], v[12:15]
    v_mfma_f32_16x16x32_bf16 v[16:19], a[16:19], v[96:99], v[16:19]
    buffer_load_dwordx4 v[96:99], v120, s[44:47], s70 offen sc1
    s_waitcnt vmcnt(13)
    v_cmp_ne_u32 vcc, 1, v126
    s_mul_i32 s13, s14, 81920
    s_lshl_b32 s69, s64, 2
    s_add_u32 s69, s69, s63
    s_lshl_b32 s67, s64, 7
    s_add_u32 s13, s13, s67
    s_add_u32 s13, s13, 13631488
    s_cmp_eq_u64 vcc, 0
    s_cselect_b32 s12, s13, 33554432
    s_mul_i32 s67, s63, 2560
    s_add_u32 m0, s67, 81920
    s_lshl_b32 s67, s69, 8
    s_add_u32 s67, s67, 16384
    v_mfma_f32_16x16x32_bf16 v[20:23], a[20:23], v[116:119], v[20:23]
    v_mfma_f32_16x16x32_bf16 v[24:27], a[24:27], v[116:119], v[24:27]
    v_lshrrev_b32 v120, 3, v127
    v_mfma_f32_16x16x32_bf16 v[28:31], a[28:31], v[116:119], v[28:31]
    v_and_b32 v121, 7, v127
    v_mfma_f32_16x16x32_bf16 v[32:35], a[32:35], v[116:119], v[32:35]
    v_lshlrev_b32 v120, 12, v120
    v_mfma_f32_16x16x32_bf16 v[36:39], a[36:39], v[116:119], v[36:39]
    v_lshl_add_u32 v120, v121, 4, v120
    v_mfma_f32_16x16x32_bf16 v[40:43], a[20:23], a[120:123], v[40:43]
    v_add_u32 v121, 31744, v120
    v_mfma_f32_16x16x32_bf16 v[44:47], a[24:27], a[120:123], v[44:47]
    v_add_u32 v122, 63488, v120
    v_mfma_f32_16x16x32_bf16 v[48:51], a[28:31], a[120:123], v[48:51]
    v_and_b32 v123, 15, v127
    v_mfma_f32_16x16x32_bf16 v[52:55], a[32:35], a[120:123], v[52:55]
    v_lshlrev_b32 v123, 4, v123
    v_mfma_f32_16x16x32_bf16 v[56:59], a[36:39], a[120:123], v[56:59]
    buffer_load_dwordx4 v120, s[44:47], s12 offen offset:0 sc1 lds
    v_mfma_f32_16x16x32_bf16 v[60:63], a[20:23], a[124:127], v[60:63]
    buffer_load_dwordx4 v121, s[44:47], s12 offen offset:1024 sc1 lds
    v_mfma_f32_16x16x32_bf16 v[64:67], a[24:27], a[124:127], v[64:67]
    s_mov_b32 exec_hi, 0
    buffer_load_dwordx4 v122, s[44:47], s12 offen offset:2048 sc1 lds
    s_mov_b32 exec_hi, -1
    v_mfma_f32_16x16x32_bf16 v[68:71], a[28:31], a[124:127], v[68:71]
    buffer_load_dword v124, v123, s[44:47], s67 offen offset:8 sc0 sc1
    v_mfma_f32_16x16x32_bf16 v[72:75], a[32:35], a[124:127], v[72:75]
    v_mfma_f32_16x16x32_bf16 v[76:79], a[36:39], a[124:127], v[76:79]
    v_mfma_f32_16x16x32_bf16 v[0:3], a[20:23], v[112:115], v[0:3]
    v_mfma_f32_16x16x32_bf16 v[4:7], a[24:27], v[112:115], v[4:7]
    v_mfma_f32_16x16x32_bf16 v[8:11], a[28:31], v[112:115], v[8:11]
    v_mfma_f32_16x16x32_bf16 v[12:15], a[32:35], v[112:115], v[12:15]
    v_mfma_f32_16x16x32_bf16 v[16:19], a[36:39], v[112:115], v[16:19]
    s_waitcnt vmcnt(15)
    v_mfma_f32_16x16x32_bf16 v[20:23], a[80:83], v[84:87], v[20:23]
    v_mfma_f32_16x16x32_bf16 v[24:27], a[84:87], v[84:87], v[24:27]
    v_lshl_add_u32 v112, v127, 4, s68
    v_mfma_f32_16x16x32_bf16 v[28:31], a[88:91], v[84:87], v[28:31]
    v_lshrrev_b32 v116, 2, v127
    v_and_b32 v119, 3, v127
    v_lshlrev_b32 v116, 7, v116
    v_lshl_add_u32 v116, v119, 3, v116
    s_lshl_b32 s66, s63, 5
    s_add_u32 s66, s66, 81920
    v_add_u32 v116, s66, v116
    v_mfma_f32_16x16x32_bf16 v[32:35], a[92:95], v[84:87], v[32:35]
    v_and_b32 v117, 15, v127
    v_mfma_f32_16x16x32_bf16 v[36:39], a[96:99], v[84:87], v[36:39]
    v_mul_u32_u24 v117, 1280, v117
    s_waitcnt vmcnt(7)
    v_mfma_f32_16x16x32_bf16 v[20:23], a[100:103], v[100:103], v[20:23]
    v_lshrrev_b32 v118, 4, v127
    v_mfma_f32_16x16x32_bf16 v[24:27], a[104:107], v[100:103], v[24:27]
    v_lshl_add_u32 v117, v118, 3, v117
    v_mfma_f32_16x16x32_bf16 v[28:31], a[108:111], v[100:103], v[28:31]
    s_xor_b32 s66, s63, 1
    s_lshl_b32 s66, s66, 12
    v_lshl_add_u32 v113, v127, 4, s66
    v_mfma_f32_16x16x32_bf16 v[32:35], a[112:115], v[100:103], v[32:35]
    s_xor_b32 s66, s63, 2
    s_lshl_b32 s66, s66, 12
    v_lshl_add_u32 v114, v127, 4, s66
    v_mfma_f32_16x16x32_bf16 v[36:39], a[116:119], v[100:103], v[36:39]
    s_xor_b32 s66, s63, 3
    s_lshl_b32 s66, s66, 12
    v_lshl_add_u32 v115, v127, 4, s66
    v_mfma_f32_16x16x32_bf16 v[40:43], a[80:83], v[88:91], v[40:43]
    v_mfma_f32_16x16x32_bf16 v[44:47], a[84:87], v[88:91], v[44:47]
    v_mfma_f32_16x16x32_bf16 v[48:51], a[88:91], v[88:91], v[48:51]
    v_mfma_f32_16x16x32_bf16 v[52:55], a[92:95], v[88:91], v[52:55]
    ds_write_b128 v112, v[20:23] offset:0
    v_mfma_f32_16x16x32_bf16 v[56:59], a[96:99], v[88:91], v[56:59]
    ds_write_b128 v112, v[24:27] offset:1024
    s_waitcnt vmcnt(6)
    v_mfma_f32_16x16x32_bf16 v[40:43], a[100:103], v[104:107], v[40:43]
    ds_write_b128 v112, v[28:31] offset:2048
    v_mfma_f32_16x16x32_bf16 v[44:47], a[104:107], v[104:107], v[44:47]
    ds_write_b128 v112, v[32:35] offset:3072
    v_mfma_f32_16x16x32_bf16 v[48:51], a[108:111], v[104:107], v[48:51]
    ds_write_b128 v112, v[36:39] offset:16384
    v_mfma_f32_16x16x32_bf16 v[52:55], a[112:115], v[104:107], v[52:55]
    v_mfma_f32_16x16x32_bf16 v[56:59], a[116:119], v[104:107], v[56:59]
    v_mfma_f32_16x16x32_bf16 v[60:63], a[80:83], v[92:95], v[60:63]
    v_mfma_f32_16x16x32_bf16 v[64:67], a[84:87], v[92:95], v[64:67]
    v_mfma_f32_16x16x32_bf16 v[68:71], a[88:91], v[92:95], v[68:71]
    v_mfma_f32_16x16x32_bf16 v[72:75], a[92:95], v[92:95], v[72:75]
    ds_write_b128 v112, v[40:43] offset:17408
    v_mfma_f32_16x16x32_bf16 v[76:79], a[96:99], v[92:95], v[76:79]
    ds_write_b128 v112, v[44:47] offset:18432
    s_waitcnt vmcnt(5)
    v_mfma_f32_16x16x32_bf16 v[60:63], a[100:103], v[108:111], v[60:63]
    ds_write_b128 v112, v[48:51] offset:19456
    v_mfma_f32_16x16x32_bf16 v[64:67], a[104:107], v[108:111], v[64:67]
    ds_write_b128 v112, v[52:55] offset:32768
    v_mfma_f32_16x16x32_bf16 v[68:71], a[108:111], v[108:111], v[68:71]
    ds_write_b128 v112, v[56:59] offset:33792
    v_mfma_f32_16x16x32_bf16 v[72:75], a[112:115], v[108:111], v[72:75]
    v_mfma_f32_16x16x32_bf16 v[76:79], a[116:119], v[108:111], v[76:79]
    v_mfma_f32_16x16x32_bf16 v[0:3], a[80:83], v[80:83], v[0:3]
    v_mfma_f32_16x16x32_bf16 v[4:7], a[84:87], v[80:83], v[4:7]
    v_mfma_f32_16x16x32_bf16 v[8:11], a[88:91], v[80:83], v[8:11]
    v_mfma_f32_16x16x32_bf16 v[12:15], a[92:95], v[80:83], v[12:15]
    ds_write_b128 v112, v[60:63] offset:34816
    v_mfma_f32_16x16x32_bf16 v[16:19], a[96:99], v[80:83], v[16:19]
    ds_write_b128 v112, v[64:67] offset:35840
    s_waitcnt vmcnt(4)
    v_mfma_f32_16x16x32_bf16 v[0:3], a[100:103], v[96:99], v[0:3]
    ds_write_b128 v112, v[68:71] offset:49152
    v_mfma_f32_16x16x32_bf16 v[4:7], a[104:107], v[96:99], v[4:7]
    ds_write_b128 v112, v[72:75] offset:50176
    v_mfma_f32_16x16x32_bf16 v[8:11], a[108:111], v[96:99], v[8:11]
    ds_write_b128 v112, v[76:79] offset:51200
    v_mfma_f32_16x16x32_bf16 v[12:15], a[112:115], v[96:99], v[12:15]
    v_mfma_f32_16x16x32_bf16 v[16:19], a[116:119], v[96:99], v[16:19]
    s_mul_i32 s15, s69, 20480
    s_mul_i32 s67, s65, 160
    s_add_u32 s15, s15, s67
    s_mov_b32 s48, s30
    s_mov_b32 s49, s31
    s_mov_b32 s50, 2621440
    s_mov_b32 s51, 0x20000
    s_cmp_lg_u32 s12, s13
    s_cbranch_scc1 L_yslow
L_yok:
    s_waitcnt vmcnt(0) lgkmcnt(0)
    s_barrier
    ds_read_b128 v[20:23], v113 offset:0
    ds_read_b128 v[40:43], v114 offset:17408
    ds_read_b128 v[60:63], v115 offset:34816
    ds_read_b64_tr_b16 v[84:85], v116 offset:0
    ds_read_b128 v[24:27], v113 offset:1024
    ds_read_b128 v[44:47], v114 offset:18432
    ds_read_b128 v[64:67], v115 offset:35840
    ds_read_b64_tr_b16 v[86:87], v116 offset:2048
    ds_read_b128 v[28:31], v113 offset:2048
    ds_read_b128 v[48:51], v114 offset:19456
    ds_read_b128 v[68:71], v115 offset:49152
    ds_read_b64_tr_b16 v[88:89], v116 offset:4096
    s_waitcnt lgkmcnt(8)
    ds_read_b128 v[32:35], v113 offset:3072
    ds_read_b128 v[52:55], v114 offset:32768
    ds_read_b128 v[72:75], v115 offset:50176
    ds_read_b64_tr_b16 v[90:91], v116 offset:6144
    v_pk_add_f32 v[0:1], v[0:1], v[20:21]
    v_pk_add_f32 v[40:41], v[40:41], v[60:61]
    v_pk_add_f32 v[2:3], v[2:3], v[22:23]
    v_pk_add_f32 v[42:43], v[42:43], v[62:63]
    v_pk_add_f32 v[0:1], v[0:1], v[40:41]
    v_pk_add_f32 v[2:3], v[2:3], v[42:43]
    v_lshlrev_b32 v100, 16, v84
    v_and_b32 v101, 0xffff0000, v84
    v_lshlrev_b32 v102, 16, v85
    v_and_b32 v103, 0xffff0000, v85
    v_pk_add_f32 v[100:101], v[100:101], v[0:1] neg_lo:[0,1] neg_hi:[0,1]
    v_pk_add_f32 v[102:103], v[102:103], v[2:3] neg_lo:[0,1] neg_hi:[0,1]
    v_pk_fma_f32 v[0:1], v[124:125], v[100:101], v[0:1] op_sel_hi:[0,1,1]
    v_pk_fma_f32 v[2:3], v[124:125], v[102:103], v[2:3] op_sel_hi:[0,1,1]
    v_cvt_pk_bf16_f32 v0, v0, v1
    v_cvt_pk_bf16_f32 v1, v2, v3
    buffer_store_dwordx2 v[0:1], v117, s[48:51], s15 offen offset:0
    s_waitcnt lgkmcnt(8)
    ds_read_b128 v[36:39], v113 offset:16384
    ds_read_b128 v[56:59], v114 offset:33792
    ds_read_b128 v[76:79], v115 offset:51200
    ds_read_b64_tr_b16 v[92:93], v116 offset:8192
    v_pk_add_f32 v[4:5], v[4:5], v[24:25]
    v_pk_add_f32 v[44:45], v[44:45], v[64:65]
    v_pk_add_f32 v[6:7], v[6:7], v[26:27]
    v_pk_add_f32 v[46:47], v[46:47], v[66:67]
    v_pk_add_f32 v[4:5], v[4:5], v[44:45]
    v_pk_add_f32 v[6:7], v[6:7], v[46:47]
    v_lshlrev_b32 v104, 16, v86
    v_and_b32 v105, 0xffff0000, v86
    v_lshlrev_b32 v106, 16, v87
    v_and_b32 v107, 0xffff0000, v87
    v_pk_add_f32 v[104:105], v[104:105], v[4:5] neg_lo:[0,1] neg_hi:[0,1]
    v_pk_add_f32 v[106:107], v[106:107], v[6:7] neg_lo:[0,1] neg_hi:[0,1]
    v_pk_fma_f32 v[4:5], v[124:125], v[104:105], v[4:5] op_sel_hi:[0,1,1]
    v_pk_fma_f32 v[6:7], v[124:125], v[106:107], v[6:7] op_sel_hi:[0,1,1]
    v_cvt_pk_bf16_f32 v4, v4, v5
    v_cvt_pk_bf16_f32 v5, v6, v7
    buffer_store_dwordx2 v[4:5], v117, s[48:51], s15 offen offset:32
    s_waitcnt lgkmcnt(8)
    v_pk_add_f32 v[8:9], v[8:9], v[28:29]
    v_pk_add_f32 v[48:49], v[48:49], v[68:69]
    v_pk_add_f32 v[10:11], v[10:11], v[30:31]
    v_pk_add_f32 v[50:51], v[50:51], v[70:71]
    v_pk_add_f32 v[8:9], v[8:9], v[48:49]
    v_pk_add_f32 v[10:11], v[10:11], v[50:51]
    v_lshlrev_b32 v100, 16, v88
    v_and_b32 v101, 0xffff0000, v88
    v_lshlrev_b32 v102, 16, v89
    v_and_b32 v103, 0xffff0000, v89
    v_pk_add_f32 v[100:101], v[100:101], v[8:9] neg_lo:[0,1] neg_hi:[0,1]
    v_pk_add_f32 v[102:103], v[102:103], v[10:11] neg_lo:[0,1] neg_hi:[0,1]
    v_pk_fma_f32 v[8:9], v[124:125], v[100:101], v[8:9] op_sel_hi:[0,1,1]
    v_pk_fma_f32 v[10:11], v[124:125], v[102:103], v[10:11] op_sel_hi:[0,1,1]
    v_cvt_pk_bf16_f32 v8, v8, v9
    v_cvt_pk_bf16_f32 v9, v10, v11
    buffer_store_dwordx2 v[8:9], v117, s[48:51], s15 offen offset:64
    s_waitcnt lgkmcnt(4)
    v_pk_add_f32 v[12:13], v[12:13], v[32:33]
    v_pk_add_f32 v[52:53], v[52:53], v[72:73]
    v_pk_add_f32 v[14:15], v[14:15], v[34:35]
    v_pk_add_f32 v[54:55], v[54:55], v[74:75]
    v_pk_add_f32 v[12:13], v[12:13], v[52:53]
    v_pk_add_f32 v[14:15], v[14:15], v[54:55]
    v_lshlrev_b32 v104, 16, v90
    v_and_b32 v105, 0xffff0000, v90
    v_lshlrev_b32 v106, 16, v91
    v_and_b32 v107, 0xffff0000, v91
    v_pk_add_f32 v[104:105], v[104:105], v[12:13] neg_lo:[0,1] neg_hi:[0,1]
    v_pk_add_f32 v[106:107], v[106:107], v[14:15] neg_lo:[0,1] neg_hi:[0,1]
    v_pk_fma_f32 v[12:13], v[124:125], v[104:105], v[12:13] op_sel_hi:[0,1,1]
    v_pk_fma_f32 v[14:15], v[124:125], v[106:107], v[14:15] op_sel_hi:[0,1,1]
    v_cvt_pk_bf16_f32 v12, v12, v13
    v_cvt_pk_bf16_f32 v13, v14, v15
    buffer_store_dwordx2 v[12:13], v117, s[48:51], s15 offen offset:96
    s_waitcnt lgkmcnt(0)
    v_pk_add_f32 v[16:17], v[16:17], v[36:37]
    v_pk_add_f32 v[56:57], v[56:57], v[76:77]
    v_pk_add_f32 v[18:19], v[18:19], v[38:39]
    v_pk_add_f32 v[58:59], v[58:59], v[78:79]
    v_pk_add_f32 v[16:17], v[16:17], v[56:57]
    v_pk_add_f32 v[18:19], v[18:19], v[58:59]
    v_lshlrev_b32 v100, 16, v92
    v_and_b32 v101, 0xffff0000, v92
    v_lshlrev_b32 v102, 16, v93
    v_and_b32 v103, 0xffff0000, v93
    v_pk_add_f32 v[100:101], v[100:101], v[16:17] neg_lo:[0,1] neg_hi:[0,1]
    v_pk_add_f32 v[102:103], v[102:103], v[18:19] neg_lo:[0,1] neg_hi:[0,1]
    v_pk_fma_f32 v[16:17], v[124:125], v[100:101], v[16:17] op_sel_hi:[0,1,1]
    v_pk_fma_f32 v[18:19], v[124:125], v[102:103], v[18:19] op_sel_hi:[0,1,1]
    v_cvt_pk_bf16_f32 v16, v16, v17
    v_cvt_pk_bf16_f32 v17, v18, v19
    buffer_store_dwordx2 v[16:17], v117, s[48:51], s15 offen offset:128
    s_endpgm
L_yslow:
    s_lshl_b32 s14, s65, 2
    s_add_u32 s14, s14, s63
    s_mul_i32 s66, s14, 2560
    s_add_u32 s66, s66, 2883584
    v_min_u32 v126, 19, v127
    v_lshl_add_u32 v126, v126, 7, s66
    buffer_load_dword v118, v126, s[44:47], 0 offen offset:0 sc0 sc1
    s_waitcnt vmcnt(0)
    s_mov_b32 s71, 40000
L_poll_42:
    v_cmp_ne_u32 vcc, 1, v118
    s_cbranch_vccz L_ok_43
    s_sleep 4
    buffer_load_dword v118, v126, s[44:47], 0 offen offset:0 sc0 sc1
    s_sub_u32 s71, s71, 1
    s_waitcnt vmcnt(0)
    s_cbranch_scc0 L_poll_42
L_ok_43:
    buffer_load_dwordx4 v120, s[44:47], s13 offen offset:0 sc1 lds
    buffer_load_dwordx4 v121, s[44:47], s13 offen offset:1024 sc1 lds
    s_mov_b32 exec_hi, 0
    buffer_load_dwordx4 v122, s[44:47], s13 offen offset:2048 sc1 lds
    s_mov_b32 exec_hi, -1
    s_branch L_yok
L_slow_1:
    s_mov_b32 s71, 40000
L_sl_3:
    ds_read_b32 v75, v73
    s_sub_u32 s71, s71, 1
    s_cbranch_scc1 L_go_2
    s_waitcnt lgkmcnt(0)
    v_cmp_gt_u32 vcc, 1, v75
    s_cbranch_vccnz L_sl_3
    s_branch L_go_2
L_slow_4:
    s_mov_b32 s71, 40000
L_sl_6:
    ds_read_b32 v75, v73
    s_sub_u32 s71, s71, 1
    s_cbranch_scc1 L_go_5
    s_waitcnt lgkmcnt(0)
    v_cmp_gt_u32 vcc, 2, v75
    s_cbranch_vccnz L_sl_6
    s_branch L_go_5
L_slow_7:
    s_mov_b32 s71, 40000
L_sl_9:
    ds_read_b32 v75, v73
    s_sub_u32 s71, s71, 1
    s_cbranch_scc1 L_go_8
    s_waitcnt lgkmcnt(0)
    v_cmp_gt_u32 vcc, 3, v75
    s_cbranch_vccnz L_sl_9
    s_branch L_go_8
L_slow_10:
    s_mov_b32 s71, 40000
L_sl_12:
    ds_read_b32 v75, v73
    s_sub_u32 s71, s71, 1
    s_cbranch_scc1 L_go_11
    s_waitcnt lgkmcnt(0)
    v_cmp_gt_u32 vcc, 4, v75
    s_cbranch_vccnz L_sl_12
    s_branch L_go_11
L_slow_13:
    s_mov_b32 s71, 40000
L_sl_15:
    ds_read_b32 v75, v73
    s_sub_u32 s71, s71, 1
    s_cbranch_scc1 L_go_14
    s_waitcnt lgkmcnt(0)
    v_cmp_gt_u32 vcc, 5, v75
    s_cbranch_vccnz L_sl_15
    s_branch L_go_14
L_slow_16:
    s_mov_b32 s71, 40000
L_sl_18:
    ds_read_b32 v75, v73
    s_sub_u32 s71, s71, 1
    s_cbranch_scc1 L_go_17
    s_waitcnt lgkmcnt(0)
    v_cmp_gt_u32 vcc, 6, v75
    s_cbranch_vccnz L_sl_18
    s_branch L_go_17
L_slow_19:
    s_mov_b32 s71, 40000
L_sl_21:
    ds_read_b32 v75, v73
    s_sub_u32 s71, s71, 1
    s_cbranch_scc1 L_go_20
    s_waitcnt lgkmcnt(0)
    v_cmp_gt_u32 vcc, 7, v75
    s_cbranch_vccnz L_sl_21
    s_branch L_go_20
L_slow_22:
    s_mov_b32 s71, 40000
L_sl_24:
    ds_read_b32 v75, v73
    s_sub_u32 s71, s71, 1
    s_cbranch_scc1 L_go_23
    s_waitcnt lgkmcnt(0)
    v_cmp_gt_u32 vcc, 8, v75
    s_cbranch_vccnz L_sl_24
    s_branch L_go_23
L_slow_25:
    s_mov_b32 s71, 40000
L_sl_27:
    ds_read_b32 v75, v73
    s_sub_u32 s71, s71, 1
    s_cbranch_scc1 L_go_26
    s_waitcnt lgkmcnt(0)
    v_cmp_gt_u32 vcc, 9, v75
    s_cbranch_vccnz L_sl_27
    s_branch L_go_26
L_slow_28:
    s_mov_b32 s71, 40000
L_sl_30:
    ds_read_b32 v75, v73
    s_sub_u32 s71, s71, 1
    s_cbranch_scc1 L_go_29
    s_waitcnt lgkmcnt(0)
    v_cmp_gt_u32 vcc, 10, v75
    s_cbranch_vccnz L_sl_30
    s_branch L_go_29
L_slow_31:
    s_mov_b32 s71, 40000
L_sl_33:
    ds_read_b32 v75, v73
    s_sub_u32 s71, s71, 1
    s_cbranch_scc1 L_go_32
    s_waitcnt lgkmcnt(0)
    v_cmp_gt_u32 vcc, 11, v75
    s_cbranch_vccnz L_sl_33
    s_branch L_go_32
L_free:
    v_add_u32 v0, 0, v127
    v_mul_u32_u24 v1, 1639, v0
    v_lshrrev_b32 v1, 16, v1
    v_mul_u32_u24 v1, 640, v1
    v_lshl_add_u32 v100, v0, 4, v1
    v_add_u32 v0, 64, v127
    v_mul_u32_u24 v1, 1639, v0
    v_lshrrev_b32 v1, 16, v1
    v_mul_u32_u24 v1, 640, v1
    v_lshl_add_u32 v101, v0, 4, v1
    v_add_u32 v0, 128, v127
    v_mul_u32_u24 v1, 1639, v0
    v_lshrrev_b32 v1, 16, v1
    v_mul_u32_u24 v1, 640, v1
    v_lshl_add_u32 v102, v0, 4, v1
    v_add_u32 v0, 192, v127
    v_mul_u32_u24 v1, 1639, v0
    v_lshrrev_b32 v1, 16, v1
    v_mul_u32_u24 v1, 640, v1
    v_lshl_add_u32 v103, v0, 4, v1
    v_add_u32 v0, 256, v127
    v_mul_u32_u24 v1, 1639, v0
    v_lshrrev_b32 v1, 16, v1
    v_mul_u32_u24 v1, 640, v1
    v_lshl_add_u32 v104, v0, 4, v1
    v_mov_b32 v126, 0
    s_waitcnt lgkmcnt(0)
    s_mov_b32 s40, s24
    s_mov_b32 s41, s25
    s_mov_b32 s42, 2211840
    s_mov_b32 s43, 0x20000
    s_barrier
    s_mul_i32 s68, s3, 10240
    s_add_u32 s68, s68, 92160
    s_mul_i32 s18, s84, 7
    s_add_u32 s18, s18, s3
    s_lshr_b32 s66, s18, 2
    s_bfe_u32 s67, s18, 0x10001
    s_and_b32 s19, s18, 1
    s_mul_i32 s69, s66, 40960
    s_mul_i32 s70, s67, 640
    s_add_u32 s69, s69, s70
    s_mul_i32 s70, s19, 20480
    s_add_u32 s69, s69, s70
    s_add_u32 m0, s68, 0
    s_nop 0
    buffer_load_dwordx4 v100, s[40:43], s69 offen nt lds
    s_add_u32 m0, s68, 1024
    s_nop 0
    buffer_load_dwordx4 v101, s[40:43], s69 offen nt lds
    s_add_u32 m0, s68, 2048
    s_nop 0
    buffer_load_dwordx4 v102, s[40:43], s69 offen nt lds
    s_add_u32 m0, s68, 3072
    s_nop 0
    buffer_load_dwordx4 v103, s[40:43], s69 offen nt lds
    s_add_u32 m0, s68, 4096
    s_nop 0
    buffer_load_dwordx4 v104, s[40:43], s69 offen nt lds
    s_add_u32 s69, s69, 10240
    s_add_u32 m0, s68, 5120
    s_nop 0
    buffer_load_dwordx4 v100, s[40:43], s69 offen nt lds
    s_add_u32 m0, s68, 6144
    s_nop 0
    buffer_load_dwordx4 v101, s[40:43], s69 offen nt lds
    s_add_u32 m0, s68, 7168
    s_nop 0
    buffer_load_dwordx4 v102, s[40:43], s69 offen nt lds
    s_add_u32 m0, s68, 8192
    s_nop 0
    buffer_load_dwordx4 v103, s[40:43], s69 offen nt lds
    s_add_u32 m0, s68, 9216
    s_nop 0
    buffer_load_dwordx4 v104, s[40:43], s69 offen nt lds
    s_mul_i32 s16, s67, 216
    s_add_u32 s16, s16, s66
    s_mul_i32 s16, s16, 10
    s_add_u32 s16, s16, s19
    s_lshl_b32 s16, s16, 9
    s_add_u32 s16, s16, 3145728
    s_lshl_b32 s17, s67, 6
    s_add_u32 s17, s17, s66
    s_lshl_b32 s17, s17, 5
    s_add_u32 s17, s17, s19
    s_lshl_b32 s17, s17, 2
    s_add_u32 s17, s17, 3047424
    s_cmp_ge_u32 s18, 216
    s_cselect_b32 s16, 33554432, s16
    s_cselect_b32 s17, 33554432, s17
    s_mov_b32 s44, s34
    s_mov_b32 s45, s35
    s_mov_b32 s46, 16777216
    s_mov_b32 s47, 0x20000
    v_bfe_u32 v0, v127, 2, 3
    v_lshrrev_b32 v2, 5, v127
    v_lshl_add_u32 v0, v0, 1, v2
    v_mul_u32_u24 v0, 320, v0
    v_and_b32 v1, 3, v127
    v_lshl_add_u32 v0, v1, 3, v0
    v_add_u32 v0, s68, v0
    v_mul_u32_u24 v2, 552448, v2
    v_lshl_add_u32 v1, v127, 4, v2
    v_add_u32 v2, 4096, v1
    s_waitcnt vmcnt(0)
    ds_read_b64_tr_b16 v[8:9], v0 offset:0
    ds_read_b64_tr_b16 v[10:11], v0 offset:5120
    ds_read_b64_tr_b16 v[12:13], v0 offset:32
    ds_read_b64_tr_b16 v[14:15], v0 offset:5152
    ds_read_b64_tr_b16 v[16:17], v0 offset:64
    ds_read_b64_tr_b16 v[18:19], v0 offset:5184
    ds_read_b64_tr_b16 v[20:21], v0 offset:96
    ds_read_b64_tr_b16 v[22:23], v0 offset:5216
    ds_read_b64_tr_b16 v[24:25], v0 offset:128
    ds_read_b64_tr_b16 v[26:27], v0 offset:5248
    s_waitcnt lgkmcnt(8)
    buffer_store_dwordx4 v[8:11], v1, s[44:47], s16 offen offset:0 sc1
    s_waitcnt lgkmcnt(6)
    buffer_store_dwordx4 v[12:15], v1, s[44:47], s16 offen offset:1024 sc1
    s_waitcnt lgkmcnt(4)
    buffer_store_dwordx4 v[16:19], v1, s[44:47], s16 offen offset:2048 sc1
    s_waitcnt lgkmcnt(2)
    buffer_store_dwordx4 v[20:23], v1, s[44:47], s16 offen offset:3072 sc1
    s_waitcnt lgkmcnt(0)
    buffer_store_dwordx4 v[24:27], v2, s[44:47], s16 offen offset:0 sc1
    ds_read_b64_tr_b16 v[28:29], v0 offset:160
    ds_read_b64_tr_b16 v[30:31], v0 offset:5280
    ds_read_b64_tr_b16 v[32:33], v0 offset:192
    ds_read_b64_tr_b16 v[34:35], v0 offset:5312
    ds_read_b64_tr_b16 v[36:37], v0 offset:224
    ds_read_b64_tr_b16 v[38:39], v0 offset:5344
    ds_read_b64_tr_b16 v[40:41], v0 offset:256
    ds_read_b64_tr_b16 v[42:43], v0 offset:5376
    ds_read_b64_tr_b16 v[44:45], v0 offset:288
    ds_read_b64_tr_b16 v[46:47], v0 offset:5408
    s_add_u32 s16, s16, 276480
    s_waitcnt lgkmcnt(8)
    buffer_store_dwordx4 v[28:31], v1, s[44:47], s16 offen offset:0 sc1
    s_waitcnt lgkmcnt(6)
    buffer_store_dwordx4 v[32:35], v1, s[44:47], s16 offen offset:1024 sc1
    s_waitcnt lgkmcnt(4)
    buffer_store_dwordx4 v[36:39], v1, s[44:47], s16 offen offset:2048 sc1
    s_waitcnt lgkmcnt(2)
    buffer_store_dwordx4 v[40:43], v1, s[44:47], s16 offen offset:3072 sc1
    s_waitcnt lgkmcnt(0)
    buffer_store_dwordx4 v[44:47], v2, s[44:47], s16 offen offset:0 sc1
    v_and_b32 v58, 31, v127
    v_lshlrev_b32 v58, 2, v58
    global_load_dword v59, v58, s[32:33] sc0 sc1
    s_waitcnt vmcnt(0)
    s_mov_b32 s71, 40000
L_poll_44:
    v_cmp_ne_u32 vcc, 1, v59
    s_cbranch_vccz L_ok_45
    s_sleep 8
    global_load_dword v59, v58, s[32:33] sc0 sc1
    s_sub_u32 s71, s71, 1
    s_waitcnt vmcnt(0)
    s_cbranch_scc0 L_poll_44
L_ok_45:
    v_mov_b32 v59, 1
    v_mov_b32 v126, 0
    s_mov_b64 exec, 1
    buffer_store_dword v59, v126, s[44:47], s17 offen offset:0 sc0 sc1
    s_mov_b64 exec, -1
    s_lshr_b32 s12, s65, 2
    s_lshl_b32 s12, s12, 13
    s_add_u32 s12, s12, 3047424
    s_mul_i32 s13, s63, 1792
    s_min_u32 s13, s13, 5120
    s_add_u32 s12, s12, s13
    v_lshrrev_b32 v115, 1, v127
    v_min_u32 v115, 13, v115
    v_and_b32 v114, 1, v127
    v_lshl_add_u32 v114, v114, 2, s12
    v_lshl_add_u32 v115, v115, 7, v114
    buffer_load_dword v114, v115, s[44:47], 0 offen offset:0 sc0 sc1
    s_mul_i32 s12, s63, 14
    s_cmp_eq_u32 s63, 3
    s_cselect_b32 s12, 41, s12
    s_cmp_ge_u32 s63, 2
    s_cselect_b32 s13, 13, 14
    s_mul_i32 s14, s55, 3
    s_lshr_b32 s14, s14, 1
    s_mul_i32 s15, s54, 3
    s_add_u32 s14, s14, s15
    s_cmp_ge_u32 s14, s13
    s_cselect_b32 s15, s13, 0
    s_sub_u32 s14, s14, s15
    s_add_u32 s13, s13, s12
    s_add_u32 s72, s12, s14
    s_add_u32 s73, s72, 1
    s_cmp_eq_u32 s73, s13
    s_cselect_b32 s73, s12, s73
    s_add_u32 s74, s73, 1
    s_cmp_eq_u32 s74, s13
    s_cselect_b32 s74, s12, s74
    s_add_u32 s75, s74, 1
    s_cmp_eq_u32 s75, s13
    s_cselect_b32 s75, s12, s75
    s_add_u32 s76, s75, 1
    s_cmp_eq_u32 s76, s13
    s_cselect_b32 s76, s12, s76
    s_add_u32 s77, s76, 1
    s_cmp_eq_u32 s77, s13
    s_cselect_b32 s77, s12, s77
    s_add_u32 s78, s77, 1
    s_cmp_eq_u32 s78, s13
    s_cselect_b32 s78, s12, s78
    s_add_u32 s79, s78, 1
    s_cmp_eq_u32 s79, s13
    s_cselect_b32 s79, s12, s79
    s_add_u32 s80, s79, 1
    s_cmp_eq_u32 s80, s13
    s_cselect_b32 s80, s12, s80
    s_add_u32 s81, s80, 1
    s_cmp_eq_u32 s81, s13
    s_cselect_b32 s81, s12, s81
    s_add_u32 s82, s81, 1
    s_cmp_eq_u32 s82, s13
    s_cselect_b32 s82, s12, s82
    s_add_u32 s83, s82, 1
    s_cmp_eq_u32 s83, s13
    s_cselect_b32 s83, s12, s83
    s_add_u32 s84, s83, 1
    s_cmp_eq_u32 s84, s13
    s_cselect_b32 s84, s12, s84
    s_add_u32 s85, s84, 1
    s_cmp_eq_u32 s85, s13
    s_cselect_b32 s85, s12, s85
    s_cmp_ge_u32 s63, 2
    s_cselect_b32 s85, 0x2000, s85
    s_mul_i32 s62, s65, 276480
    s_add_u32 s62, s62, 3145728
    s_mul_i32 s61, s64, 221184
    s_add_u32 s61, s61, 6291456
    v_lshlrev_b32 v124, 4, v127
    v_add_u32 v125, 4096, v124
    s_lshl_b32 s68, s63, 12
    v_add_u32 v126, s68, v124
    v_add_u32 v126, 16384, v126
    s_branch L_pre2
L_aux:
    s_lshl_b32 s61, s56, 4
    s_add_u32 s61, s61, s59
    s_lshl_b32 s61, s61, 2
    s_add_u32 s61, s61, s63
    s_lshl_b32 s61, s61, 1
    v_lshrrev_b32 v50, 5, v127
    v_add_u32 v50, s61, v50
    v_mul_u32_u24 v50, 1280, v50
    v_and_b32 v51, 31, v127
    v_lshlrev_b32 v51, 3, v51
    v_add_u32 v50, v50, v51
    s_mul_i32 s62, s52, 20
    s_add_u32 s62, s62, s53
    s_sub_u32 s62, s62, 8
    s_lshl_b32 s62, s62, 2
    s_add_u32 s62, s62, s63
    s_sub_u32 s67, s55, 2
    s_cmp_lt_u32 s67, 5
    s_cselect_b32 s62, s62, 0
    s_lshl_b32 s66, s62, 8
    v_lshl_add_u32 v52, v127, 2, s66
    s_lshl_b32 s66, s62, 1
    v_mov_b32 v53, s66
    v_mov_b32 v126, 0
    s_lshl_b32 s68, s63, 14
    s_add_u32 s68, s68, 98304
    s_cmp_lt_u32 s67, 5
    s_cbranch_scc1 L_conv
    s_cmp_eq_u32 s55, 7
    s_cbranch_scc1 L_auxfree
    s_barrier
    s_waitcnt lgkmcnt(0)
    s_mov_b32 s44, s34
    s_mov_b32 s45, s35
    s_mov_b32 s46, 16777216
    s_mov_b32 s47, 0x20000
    v_lshrrev_b32 v1, 4, v127
    v_bfe_u32 v62, v127, 2, 2
    v_bfe_u32 v56, v127, 1, 1
    s_lshl_b32 s69, s63, 1
    v_add_u32 v56, s69, v56
    v_lshlrev_b32 v57, 1, v62
    v_xor_b32 v56, v56, v57
    v_lshlrev_b32 v56, 4, v56
    v_and_b32 v57, 1, v127
    v_lshl_add_u32 v56, v57, 3, v56
    v_lshl_add_u32 v56, v62, 9, v56
    v_lshl_add_u32 v56, v1, 12, v56
    v_xor_b32 v57, 16, v56
    v_and_b32 v0, 3, v127
    v_lshlrev_b32 v0, 4, v0
    v_lshl_add_u32 v0, v1, 6, v0
    v_lshl_add_u32 v62, v62, 14, v0
    s_add_u32 s13, s60, s85
    s_lshl_b32 s13, s13, 2
    s_add_u32 s13, s13, s63
    s_lshl_b32 s12, s13, 6
    s_add_u32 s12, s12, s56
    s_lshl_b32 s12, s12, 10
    s_add_u32 s12, s12, 131072
    s_lshl_b32 s13, s13, 4
    s_add_u32 s13, s13, s56
    s_lshl_b32 s13, s13, 7
    s_add_u32 s13, s13, 2965504
    s_cmp_eq_u32 s85, 6
    s_cselect_b32 s12, 33554432, s12
    s_cselect_b32 s13, 33554432, s13
    v_and_b32 v0, 31, v127
    v_lshl_add_u32 v63, v0, 2, s68
    v_and_b32 v1, 3, v127
    v_lshlrev_b32 v1, 14, v1
    v_lshl_add_u32 v1, v0, 2, v1
    v_add_u32 v61, 114368, v1
    s_cmp_eq_u32 s63, 0
    s_cselect_b32 s14, 7, 99
    s_add_u32 s15, s85, 1
    s_lshl_b32 s66, s85, 14
    s_cmp_eq_u32 s85, 3
    s_cselect_b32 s66, 0, s66
    v_add_u32 v56, s66, v56
    v_add_u32 v57, s66, v57
    s_cmp_eq_u32 s85, 6
    s_cbranch_scc1 L_utp_46
    ds_read_b32 v122, v61
    v_mov_b32 v123, s14
    s_waitcnt lgkmcnt(0)
    v_cmp_gt_u32 vcc, s15, v122
    s_cbranch_vccnz L_slow_47
L_go_48:
    ds_read_b64_tr_b16 v[106:107], v56 offset:0
    ds_read_b64_tr_b16 v[108:109], v56 offset:2048
    ds_read_b64_tr_b16 v[110:111], v56 offset:128
    ds_read_b64_tr_b16 v[112:113], v56 offset:2176
    ds_read_b64_tr_b16 v[114:115], v57 offset:256
    ds_read_b64_tr_b16 v[116:117], v57 offset:2304
    ds_read_b64_tr_b16 v[118:119], v57 offset:384
    ds_read_b64_tr_b16 v[120:121], v57 offset:2432
    ds_write_b32 v63, v123 offset:16192
    s_waitcnt lgkmcnt(1)
    buffer_store_dwordx4 v[106:109], v62, s[44:47], s12 offen offset:0 sc1
    buffer_store_dwordx4 v[110:113], v62, s[44:47], s12 offen offset:256 sc1
    buffer_store_dwordx4 v[114:117], v62, s[44:47], s12 offen offset:512 sc1
    buffer_store_dwordx4 v[118:121], v62, s[44:47], s12 offen offset:768 sc1
L_utp_46:
    ds_read_b32 v122, v61
    s_waitcnt lgkmcnt(0)
    v_cmp_gt_u32 vcc, 2, v122
    s_cbranch_vccnz L_slow_50
L_go_51:
    v_and_b32 v58, 31, v127
    v_lshlrev_b32 v58, 2, v58
    s_cmp_lg_u32 s63, 0
    s_cbranch_scc1 L_d0_53
    global_load_dword v59, v58, s[32:33] sc0 sc1
L_d0_53:
    ds_read_b32 v122, v61
    s_waitcnt lgkmcnt(0)
    v_cmp_gt_u32 vcc, 3, v122
    s_cbranch_vccnz L_slow_54
L_go_55:
    global_load_dwordx2 v[80:81], v50, s[4:5] offset:0
    global_load_dwordx2 v[82:83], v50, s[4:5] offset:256
    global_load_dwordx2 v[84:85], v50, s[4:5] offset:512
    global_load_dwordx2 v[86:87], v50, s[4:5] offset:768
    global_load_dwordx2 v[88:89], v50, s[4:5] offset:1024
    global_load_dwordx2 v[90:91], v51, s[28:29] offset:0
    global_load_dwordx2 v[92:93], v51, s[28:29] offset:256
    global_load_dwordx2 v[94:95], v51, s[28:29] offset:512
    global_load_dwordx2 v[96:97], v51, s[28:29] offset:768
    global_load_dwordx2 v[98:99], v51, s[28:29] offset:1024
    s_waitcnt vmcnt(0)
    s_cmp_lg_u32 s63, 0
    s_cbranch_scc1 L_p0_57
    s_mov_b32 s71, 40000
L_poll_58:
    v_cmp_ne_u32 vcc, 1, v59
    s_cbranch_vccz L_ok_59
    s_sleep 8
    global_load_dword v59, v58, s[32:33] sc0 sc1
    s_sub_u32 s71, s71, 1
    s_waitcnt vmcnt(0)
    s_cbranch_scc0 L_poll_58
L_ok_59:
L_p0_57:
    v_mov_b32 v59, 99
    ds_write_b32 v63, v59 offset:16192
    v_mov_b32 v123, 114496
    ds_read_b32 v122, v123
    v_mov_b32 v52, 0
    v_mov_b32 v53, 0
    v_mov_b32 v54, 0
    v_mov_b32 v55, 0x3f803f80
    v_dot2c_f32_bf16 v52, v80, v55
    v_dot2c_f32_bf16 v53, v80, v80
    v_dot2c_f32_bf16 v54, v80, v90
    v_dot2c_f32_bf16 v52, v81, v55
    v_dot2c_f32_bf16 v53, v81, v81
    v_dot2c_f32_bf16 v54, v81, v91
    v_dot2c_f32_bf16 v52, v82, v55
    v_dot2c_f32_bf16 v53, v82, v82
    v_dot2c_f32_bf16 v54, v82, v92
    v_dot2c_f32_bf16 v52, v83, v55
    v_dot2c_f32_bf16 v53, v83, v83
    v_dot2c_f32_bf16 v54, v83, v93
    v_dot2c_f32_bf16 v52, v84, v55
    v_dot2c_f32_bf16 v53, v84, v84
    v_dot2c_f32_bf16 v54, v84, v94
    v_dot2c_f32_bf16 v52, v85, v55
    v_dot2c_f32_bf16 v53, v85, v85
    v_dot2c_f32_bf16 v54, v85, v95
    v_dot2c_f32_bf16 v52, v86, v55
    v_dot2c_f32_bf16 v53, v86, v86
    v_dot2c_f32_bf16 v54, v86, v96
    v_dot2c_f32_bf16 v52, v87, v55
    v_dot2c_f32_bf16 v53, v87, v87
    v_dot2c_f32_bf16 v54, v87, v97
    v_dot2c_f32_bf16 v52, v88, v55
    v_dot2c_f32_bf16 v53, v88, v88
    v_dot2c_f32_bf16 v54, v88, v98
    v_dot2c_f32_bf16 v52, v89, v55
    v_dot2c_f32_bf16 v53, v89, v89
    v_dot2c_f32_bf16 v54, v89, v99
    s_nop 2
    v_add_f32_dpp v52, v52, v52 row_ror:8 row_mask:0xf bank_mask:0xf
    v_add_f32_dpp v53, v53, v53 row_ror:8 row_mask:0xf bank_mask:0xf
    v_add_f32_dpp v54, v54, v54 row_ror:8 row_mask:0xf bank_mask:0xf
    v_add_f32_dpp v52, v52, v52 row_ror:4 row_mask:0xf bank_mask:0xf
    v_add_f32_dpp v53, v53, v53 row_ror:4 row_mask:0xf bank_mask:0xf
    v_add_f32_dpp v54, v54, v54 row_ror:4 row_mask:0xf bank_mask:0xf
    v_add_f32_dpp v52, v52, v52 row_ror:2 row_mask:0xf bank_mask:0xf
    v_add_f32_dpp v53, v53, v53 row_ror:2 row_mask:0xf bank_mask:0xf
    v_add_f32_dpp v54, v54, v54 row_ror:2 row_mask:0xf bank_mask:0xf
    v_add_f32_dpp v52, v52, v52 row_ror:1 row_mask:0xf bank_mask:0xf
    v_add_f32_dpp v53, v53, v53 row_ror:1 row_mask:0xf bank_mask:0xf
    v_add_f32_dpp v54, v54, v54 row_ror:1 row_mask:0xf bank_mask:0xf
    v_mov_b32 v56, v52
    s_nop 1
    v_permlane16_swap_b32 v52, v56
    v_add_f32 v52, v52, v56
    v_mov_b32 v56, v53
    s_nop 1
    v_permlane16_swap_b32 v53, v56
    v_add_f32 v53, v53, v56
    v_mov_b32 v56, v54
    s_nop 1
    v_permlane16_swap_b32 v54, v56
    v_add_f32 v54, v54, v56
    v_mul_f32 v52, 0x3acccccd, v52
    v_mul_f32 v53, 0x3acccccd, v53
    v_fma_f32 v53, -v52, v52, v53
    v_max_f32 v53, 0, v53
    v_add_f32 v53, 0x3727c5ac, v53
    v_rsq_f32 v53, v53
    v_mul_f32 v54, 0xbfb8aa3b, v54
    v_exp_f32 v54, v54
    s_nop 0
    v_add_f32 v54, 1.0, v54
    v_rcp_f32 v54, v54
    s_waitcnt lgkmcnt(0)
    v_cmp_gt_u32 vcc, 99, v122
    s_cbranch_vccnz L_slow_60
L_go_61:
    v_lshrrev_b32 v56, 5, v127
    v_lshlrev_b32 v56, 4, v56
    s_lshl_b32 s66, s61, 4
    s_add_u32 s66, s66, 16384
    s_mov_b32 exec_lo, 1
    s_mov_b32 exec_hi, 1
    buffer_store_dwordx4 v[52:55], v56, s[44:47], s66 offen sc0 sc1
    s_mov_b64 exec, -1
    v_mov_b32 v59, 1
    v_mov_b32 v126, 0
    s_mov_b64 exec, 1
    buffer_store_dword v59, v126, s[44:47], s13 offen offset:0 sc0 sc1
    s_mov_b64 exec, -1
    s_endpgm
L_auxfree:
    s_cmp_eq_u32 s3, 7
    s_cbranch_scc1 L_zero
    v_add_u32 v0, 0, v127
    v_mul_u32_u24 v1, 1639, v0
    v_lshrrev_b32 v1, 16, v1
    v_mul_u32_u24 v1, 640, v1
    v_lshl_add_u32 v100, v0, 4, v1
    v_add_u32 v0, 64, v127
    v_mul_u32_u24 v1, 1639, v0
    v_lshrrev_b32 v1, 16, v1
    v_mul_u32_u24 v1, 640, v1
    v_lshl_add_u32 v101, v0, 4, v1
    v_add_u32 v0, 128, v127
    v_mul_u32_u24 v1, 1639, v0
    v_lshrrev_b32 v1, 16, v1
    v_mul_u32_u24 v1, 640, v1
    v_lshl_add_u32 v102, v0, 4, v1
    v_add_u32 v0, 192, v127
    v_mul_u32_u24 v1, 1639, v0
    v_lshrrev_b32 v1, 16, v1
    v_mul_u32_u24 v1, 640, v1
    v_lshl_add_u32 v103, v0, 4, v1
    v_add_u32 v0, 256, v127
    v_mul_u32_u24 v1, 1639, v0
    v_lshrrev_b32 v1, 16, v1
    v_mul_u32_u24 v1, 640, v1
    v_lshl_add_u32 v104, v0, 4, v1
    s_waitcnt lgkmcnt(0)
    s_mov_b32 s40, s24
    s_mov_b32 s41, s25
    s_mov_b32 s42, 2211840
    s_mov_b32 s43, 0x20000
    s_barrier
    s_mul_i32 s68, s3, 10240
    s_add_u32 s68, s68, 92160
    s_mul_i32 s18, s84, 7
    s_add_u32 s18, s18, s3
    s_lshr_b32 s66, s18, 2
    s_bfe_u32 s67, s18, 0x10001
    s_and_b32 s19, s18, 1
    s_mul_i32 s69, s66, 40960
    s_mul_i32 s70, s67, 640
    s_add_u32 s69, s69, s70
    s_mul_i32 s70, s19, 20480
    s_add_u32 s69, s69, s70
    s_add_u32 m0, s68, 0
    s_nop 0
    buffer_load_dwordx4 v100, s[40:43], s69 offen nt lds
    s_add_u32 m0, s68, 1024
    s_nop 0
    buffer_load_dwordx4 v101, s[40:43], s69 offen nt lds
    s_add_u32 m0, s68, 2048
    s_nop 0
    buffer_load_dwordx4 v102, s[40:43], s69 offen nt lds
    s_add_u32 m0, s68, 3072
    s_nop 0
    buffer_load_dwordx4 v103, s[40:43], s69 offen nt lds
    s_add_u32 m0, s68, 4096
    s_nop 0
    buffer_load_dwordx4 v104, s[40:43], s69 offen nt lds
    s_add_u32 s69, s69, 10240
    s_add_u32 m0, s68, 5120
    s_nop 0
    buffer_load_dwordx4 v100, s[40:43], s69 offen nt lds
    s_add_u32 m0, s68, 6144
    s_nop 0
    buffer_load_dwordx4 v101, s[40:43], s69 offen nt lds
    s_add_u32 m0, s68, 7168
    s_nop 0
    buffer_load_dwordx4 v102, s[40:43], s69 offen nt lds
    s_add_u32 m0, s68, 8192
    s_nop 0
    buffer_load_dwordx4 v103, s[40:43], s69 offen nt lds
    s_add_u32 m0, s68, 9216
    s_nop 0
    buffer_load_dwordx4 v104, s[40:43], s69 offen nt lds
    s_mul_i32 s16, s67, 216
    s_add_u32 s16, s16, s66
    s_mul_i32 s16, s16, 10
    s_add_u32 s16, s16, s19
    s_lshl_b32 s16, s16, 9
    s_add_u32 s16, s16, 3145728
    s_lshl_b32 s17, s67, 6
    s_add_u32 s17, s17, s66
    s_lshl_b32 s17, s17, 5
    s_add_u32 s17, s17, s19
    s_lshl_b32 s17, s17, 2
    s_add_u32 s17, s17, 3047424
    s_cmp_ge_u32 s18, 216
    s_cselect_b32 s16, 33554432, s16
    s_cselect_b32 s17, 33554432, s17
    s_mov_b32 s44, s34
    s_mov_b32 s45, s35
    s_mov_b32 s46, 16777216
    s_mov_b32 s47, 0x20000
    v_bfe_u32 v0, v127, 2, 3
    v_lshrrev_b32 v2, 5, v127
    v_lshl_add_u32 v0, v0, 1, v2
    v_mul_u32_u24 v0, 320, v0
    v_and_b32 v1, 3, v127
    v_lshl_add_u32 v0, v1, 3, v0
    v_add_u32 v0, s68, v0
    v_mul_u32_u24 v2, 552448, v2
    v_lshl_add_u32 v1, v127, 4, v2
    v_add_u32 v2, 4096, v1
    s_waitcnt vmcnt(0)
    ds_read_b64_tr_b16 v[8:9], v0 offset:0
    ds_read_b64_tr_b16 v[10:11], v0 offset:5120
    ds_read_b64_tr_b16 v[12:13], v0 offset:32
    ds_read_b64_tr_b16 v[14:15], v0 offset:5152
    ds_read_b64_tr_b16 v[16:17], v0 offset:64
    ds_read_b64_tr_b16 v[18:19], v0 offset:5184
    ds_read_b64_tr_b16 v[20:21], v0 offset:96
    ds_read_b64_tr_b16 v[22:23], v0 offset:5216
    ds_read_b64_tr_b16 v[24:25], v0 offset:128
    ds_read_b64_tr_b16 v[26:27], v0 offset:5248
    s_waitcnt lgkmcnt(8)
    buffer_store_dwordx4 v[8:11], v1, s[44:47], s16 offen offset:0 sc1
    s_waitcnt lgkmcnt(6)
    buffer_store_dwordx4 v[12:15], v1, s[44:47], s16 offen offset:1024 sc1
    s_waitcnt lgkmcnt(4)
    buffer_store_dwordx4 v[16:19], v1, s[44:47], s16 offen offset:2048 sc1
    s_waitcnt lgkmcnt(2)
    buffer_store_dwordx4 v[20:23], v1, s[44:47], s16 offen offset:3072 sc1
    s_waitcnt lgkmcnt(0)
    buffer_store_dwordx4 v[24:27], v2, s[44:47], s16 offen offset:0 sc1
    ds_read_b64_tr_b16 v[28:29], v0 offset:160
    ds_read_b64_tr_b16 v[30:31], v0 offset:5280
    ds_read_b64_tr_b16 v[32:33], v0 offset:192
    ds_read_b64_tr_b16 v[34:35], v0 offset:5312
    ds_read_b64_tr_b16 v[36:37], v0 offset:224
    ds_read_b64_tr_b16 v[38:39], v0 offset:5344
    ds_read_b64_tr_b16 v[40:41], v0 offset:256
    ds_read_b64_tr_b16 v[42:43], v0 offset:5376
    ds_read_b64_tr_b16 v[44:45], v0 offset:288
    ds_read_b64_tr_b16 v[46:47], v0 offset:5408
    s_add_u32 s16, s16, 276480
    s_waitcnt lgkmcnt(8)
    buffer_store_dwordx4 v[28:31], v1, s[44:47], s16 offen offset:0 sc1
    s_waitcnt lgkmcnt(6)
    buffer_store_dwordx4 v[32:35], v1, s[44:47], s16 offen offset:1024 sc1
    s_waitcnt lgkmcnt(4)
    buffer_store_dwordx4 v[36:39], v1, s[44:47], s16 offen offset:2048 sc1
    s_waitcnt lgkmcnt(2)
    buffer_store_dwordx4 v[40:43], v1, s[44:47], s16 offen offset:3072 sc1
    s_waitcnt lgkmcnt(0)
    buffer_store_dwordx4 v[44:47], v2, s[44:47], s16 offen offset:0 sc1
L_zdone:
    v_and_b32 v58, 31, v127
    v_lshlrev_b32 v58, 2, v58
    global_load_dword v59, v58, s[32:33] sc0 sc1
    global_load_dwordx2 v[80:81], v50, s[4:5] offset:0
    global_load_dwordx2 v[82:83], v50, s[4:5] offset:256
    global_load_dwordx2 v[84:85], v50, s[4:5] offset:512
    global_load_dwordx2 v[86:87], v50, s[4:5] offset:768
    global_load_dwordx2 v[88:89], v50, s[4:5] offset:1024
    global_load_dwordx2 v[90:91], v51, s[28:29] offset:0
    global_load_dwordx2 v[92:93], v51, s[28:29] offset:256
    global_load_dwordx2 v[94:95], v51, s[28:29] offset:512
    global_load_dwordx2 v[96:97], v51, s[28:29] offset:768
    global_load_dwordx2 v[98:99], v51, s[28:29] offset:1024
    s_waitcnt vmcnt(10)
    s_mov_b32 s71, 40000
L_poll_63:
    v_cmp_ne_u32 vcc, 1, v59
    s_cbranch_vccz L_ok_64
    s_sleep 8
    global_load_dword v59, v58, s[32:33] sc0 sc1
    s_sub_u32 s71, s71, 1
    s_waitcnt vmcnt(0)
    s_cbranch_scc0 L_poll_63
L_ok_64:
    v_mov_b32 v59, 1
    v_mov_b32 v126, 0
    s_mov_b64 exec, 1
    buffer_store_dword v59, v126, s[44:47], s17 offen offset:0 sc0 sc1
    s_mov_b64 exec, -1
    s_waitcnt vmcnt(1)
    v_mov_b32 v52, 0
    v_mov_b32 v53, 0
    v_mov_b32 v54, 0
    v_mov_b32 v55, 0x3f803f80
    v_dot2c_f32_bf16 v52, v80, v55
    v_dot2c_f32_bf16 v53, v80, v80
    v_dot2c_f32_bf16 v54, v80, v90
    v_dot2c_f32_bf16 v52, v81, v55
    v_dot2c_f32_bf16 v53, v81, v81
    v_dot2c_f32_bf16 v54, v81, v91
    v_dot2c_f32_bf16 v52, v82, v55
    v_dot2c_f32_bf16 v53, v82, v82
    v_dot2c_f32_bf16 v54, v82, v92
    v_dot2c_f32_bf16 v52, v83, v55
    v_dot2c_f32_bf16 v53, v83, v83
    v_dot2c_f32_bf16 v54, v83, v93
    v_dot2c_f32_bf16 v52, v84, v55
    v_dot2c_f32_bf16 v53, v84, v84
    v_dot2c_f32_bf16 v54, v84, v94
    v_dot2c_f32_bf16 v52, v85, v55
    v_dot2c_f32_bf16 v53, v85, v85
    v_dot2c_f32_bf16 v54, v85, v95
    v_dot2c_f32_bf16 v52, v86, v55
    v_dot2c_f32_bf16 v53, v86, v86
    v_dot2c_f32_bf16 v54, v86, v96
    v_dot2c_f32_bf16 v52, v87, v55
    v_dot2c_f32_bf16 v53, v87, v87
    v_dot2c_f32_bf16 v54, v87, v97
    v_dot2c_f32_bf16 v52, v88, v55
    v_dot2c_f32_bf16 v53, v88, v88
    v_dot2c_f32_bf16 v54, v88, v98
    v_dot2c_f32_bf16 v52, v89, v55
    v_dot2c_f32_bf16 v53, v89, v89
    v_dot2c_f32_bf16 v54, v89, v99
    s_nop 2
    v_add_f32_dpp v52, v52, v52 row_ror:8 row_mask:0xf bank_mask:0xf
    v_add_f32_dpp v53, v53, v53 row_ror:8 row_mask:0xf bank_mask:0xf
    v_add_f32_dpp v54, v54, v54 row_ror:8 row_mask:0xf bank_mask:0xf
    v_add_f32_dpp v52, v52, v52 row_ror:4 row_mask:0xf bank_mask:0xf
    v_add_f32_dpp v53, v53, v53 row_ror:4 row_mask:0xf bank_mask:0xf
    v_add_f32_dpp v54, v54, v54 row_ror:4 row_mask:0xf bank_mask:0xf
    v_add_f32_dpp v52, v52, v52 row_ror:2 row_mask:0xf bank_mask:0xf
    v_add_f32_dpp v53, v53, v53 row_ror:2 row_mask:0xf bank_mask:0xf
    v_add_f32_dpp v54, v54, v54 row_ror:2 row_mask:0xf bank_mask:0xf
    v_add_f32_dpp v52, v52, v52 row_ror:1 row_mask:0xf bank_mask:0xf
    v_add_f32_dpp v53, v53, v53 row_ror:1 row_mask:0xf bank_mask:0xf
    v_add_f32_dpp v54, v54, v54 row_ror:1 row_mask:0xf bank_mask:0xf
    v_mov_b32 v56, v52
    s_nop 1
    v_permlane16_swap_b32 v52, v56
    v_add_f32 v52, v52, v56
    v_mov_b32 v56, v53
    s_nop 1
    v_permlane16_swap_b32 v53, v56
    v_add_f32 v53, v53, v56
    v_mov_b32 v56, v54
    s_nop 1
    v_permlane16_swap_b32 v54, v56
    v_add_f32 v54, v54, v56
    v_mul_f32 v52, 0x3acccccd, v52
    v_mul_f32 v53, 0x3acccccd, v53
    v_fma_f32 v53, -v52, v52, v53
    v_max_f32 v53, 0, v53
    v_add_f32 v53, 0x3727c5ac, v53
    v_rsq_f32 v53, v53
    v_mul_f32 v54, 0xbfb8aa3b, v54
    v_exp_f32 v54, v54
    s_nop 0
    v_add_f32 v54, 1.0, v54
    v_rcp_f32 v54, v54
    v_lshrrev_b32 v56, 5, v127
    v_lshlrev_b32 v56, 4, v56
    s_lshl_b32 s66, s61, 4
    s_add_u32 s66, s66, 16384
    s_mov_b32 exec_lo, 1
    s_mov_b32 exec_hi, 1
    buffer_store_dwordx4 v[52:55], v56, s[44:47], s66 offen sc0 sc1
    s_mov_b64 exec, -1
    s_endpgm
L_zero:
    s_waitcnt lgkmcnt(0)
    s_mov_b32 s44, s34
    s_mov_b32 s45, s35
    s_mov_b32 s46, 16777216
    s_mov_b32 s47, 0x20000
    s_mov_b32 s17, 33554432
    s_waitcnt vmcnt(0)
    global_load_dwordx2 v[80:81], v50, s[4:5] offset:0
    global_load_dwordx2 v[82:83], v50, s[4:5] offset:256
    global_load_dwordx2 v[84:85], v50, s[4:5] offset:512
    global_load_dwordx2 v[86:87], v50, s[4:5] offset:768
    global_load_dwordx2 v[88:89], v50, s[4:5] offset:1024
    global_load_dwordx2 v[90:91], v51, s[28:29] offset:0
    global_load_dwordx2 v[92:93], v51, s[28:29] offset:256
    global_load_dwordx2 v[94:95], v51, s[28:29] offset:512
    global_load_dwordx2 v[96:97], v51, s[28:29] offset:768
    global_load_dwordx2 v[98:99], v51, s[28:29] offset:1024
    s_waitcnt vmcnt(0)
    s_barrier
    s_waitcnt vmcnt(0)
    s_branch L_zdone
L_conv:
    s_waitcnt lgkmcnt(0)
    global_load_ushort v44, v53, s[14:15]
    global_load_dword v40, v52, s[6:7]
    global_load_dword v41, v52, s[8:9]
    global_load_dword v42, v52, s[10:11]
    global_load_dword v43, v52, s[12:13]
    global_load_ushort v48, v53, s[16:17]
    s_barrier
    s_mov_b32 s44, s34
    s_mov_b32 s45, s35
    s_mov_b32 s46, 16777216
    s_mov_b32 s47, 0x20000
    v_lshl_add_u32 v45, v127, 2, s68
    v_and_b32 v0, 31, v127
    v_lshrrev_b32 v1, 5, v127
    v_lshl_add_u32 v49, v1, 4, s68
    v_add_u32 v2, 27, v0
    v_mul_u32_u24 v2, 272, v2
    v_add_u32 v47, v2, v49
    v_lshrrev_b32 v2, 2, v0
    v_add_u32 v2, -1, v2
    v_min_i32 v2, 5, v2
    v_cmp_gt_u32 vcc, 12, v0
    s_nop 1
    v_cndmask_b32 v2, v2, v126, vcc
    v_sub_u32 v2, v0, v2
    v_mul_u32_u24 v2, 272, v2
    v_add_u32 v46, v2, v49
    v_lshrrev_b32 v1, 4, v127
    v_bfe_u32 v62, v127, 2, 2
    v_bfe_u32 v56, v127, 1, 1
    s_lshl_b32 s69, s63, 1
    v_add_u32 v56, s69, v56
    v_lshlrev_b32 v57, 1, v62
    v_xor_b32 v56, v56, v57
    v_lshlrev_b32 v56, 4, v56
    v_and_b32 v57, 1, v127
    v_lshl_add_u32 v56, v57, 3, v56
    v_lshl_add_u32 v56, v62, 9, v56
    v_lshl_add_u32 v56, v1, 12, v56
    v_xor_b32 v57, 16, v56
    v_and_b32 v0, 3, v127
    v_lshlrev_b32 v0, 4, v0
    v_lshl_add_u32 v0, v1, 6, v0
    v_lshl_add_u32 v62, v62, 14, v0
    s_add_u32 s13, s60, s85
    s_lshl_b32 s13, s13, 2
    s_add_u32 s13, s13, s63
    s_lshl_b32 s12, s13, 6
    s_add_u32 s12, s12, s56
    s_lshl_b32 s12, s12, 10
    s_add_u32 s12, s12, 131072
    s_lshl_b32 s13, s13, 4
    s_add_u32 s13, s13, s56
    s_lshl_b32 s13, s13, 7
    s_add_u32 s13, s13, 2965504
    s_cmp_eq_u32 s85, 6
    s_cselect_b32 s12, 33554432, s12
    s_cselect_b32 s13, 33554432, s13
    v_and_b32 v0, 31, v127
    v_lshl_add_u32 v63, v0, 2, s68
    v_and_b32 v1, 3, v127
    v_lshlrev_b32 v1, 14, v1
    v_lshl_add_u32 v1, v0, 2, v1
    v_add_u32 v61, 114368, v1
    s_cmp_eq_u32 s63, 0
    s_cselect_b32 s14, 7, 99
    s_waitcnt vmcnt(0)
    s_cmp_lg_u32 s85, 0
    s_cbranch_scc1 L_utp_65
    ds_read_b32 v122, v61
    v_mov_b32 v123, s14
    s_waitcnt lgkmcnt(0)
    v_cmp_gt_u32 vcc, 1, v122
    s_cbranch_vccnz L_slow_66
L_go_67:
    ds_read_b64_tr_b16 v[106:107], v56 offset:0
    ds_read_b64_tr_b16 v[108:109], v56 offset:2048
    ds_read_b64_tr_b16 v[110:111], v56 offset:128
    ds_read_b64_tr_b16 v[112:113], v56 offset:2176
    ds_read_b64_tr_b16 v[114:115], v57 offset:256
    ds_read_b64_tr_b16 v[116:117], v57 offset:2304
    ds_read_b64_tr_b16 v[118:119], v57 offset:384
    ds_read_b64_tr_b16 v[120:121], v57 offset:2432
    ds_write_b32 v63, v123 offset:16192
    s_waitcnt lgkmcnt(1)
    buffer_store_dwordx4 v[106:109], v62, s[44:47], s12 offen offset:0 sc1
    buffer_store_dwordx4 v[110:113], v62, s[44:47], s12 offen offset:256 sc1
    buffer_store_dwordx4 v[114:117], v62, s[44:47], s12 offen offset:512 sc1
    buffer_store_dwordx4 v[118:121], v62, s[44:47], s12 offen offset:768 sc1
L_utp_65:
    v_lshlrev_b32 v44, 16, v44
    v_lshlrev_b32 v48, 16, v48
    v_mul_f32 v0, 0x3fb8aa3b, v44
    s_mov_b32 s70, 0x3fb8aa3b
    v_fma_f32 v1, v44, s70, -v0
    v_fmac_f32 v1, 0x32a57060, v44
    v_exp_f32 v0, v0
    v_mul_f32 v1, 0x3f317218, v1
    v_fmac_f32 v0, v0, v1
    v_cvt_pk_bf16_f32 v0, v0, v0
    v_lshlrev_b32 v44, 16, v0
    v_lshlrev_b32 v0, 16, v40
    v_mul_f32 v1, 0x3fb8aa3b, v0
    s_mov_b32 s70, 0x3fb8aa3b
    v_fma_f32 v2, v0, s70, -v1
    v_fmac_f32 v2, 0x32a57060, v0
    v_exp_f32 v1, v1
    v_mul_f32 v2, 0x3f317218, v2
    v_fmac_f32 v1, v1, v2
    v_cvt_pk_bf16_f32 v1, v1, v1
    v_lshlrev_b32 v0, 16, v1
    v_mul_f32 v0, v0, v44
    v_mul_f32 v0, 0xbfb8aa3b, v0
    v_lshlrev_b32 v1, 16, v41
    v_mul_f32 v1, v1, v44
    v_mul_f32 v1, 0x3e22f983, v1
    v_mul_f32 v2, 0x3f800000, v0
    v_mul_f32 v3, 0x3f800000, v1
    v_exp_f32 v2, v2
    v_fract_f32 v3, v3
    v_cos_f32 v4, v3
    v_sin_f32 v5, v3
    v_mul_f32 v4, v4, v2
    v_mul_f32 v5, v5, v2
    v_sub_f32 v6, 0, v5
    v_mul_f32 v2, 0x41000000, v0
    v_mul_f32 v3, 0x41000000, v1
    v_exp_f32 v2, v2
    v_fract_f32 v3, v3
    v_cos_f32 v8, v3
    v_sin_f32 v9, v3
    v_mul_f32 v8, v8, v2
    v_mul_f32 v9, v9, v2
    v_sub_f32 v10, 0, v9
    v_mul_f32 v2, 0x43800000, v0
    v_mul_f32 v3, 0x43800000, v1
    v_exp_f32 v2, v2
    v_fract_f32 v3, v3
    v_cos_f32 v12, v3
    v_sin_f32 v13, v3
    v_mul_f32 v12, v12, v2
    v_mul_f32 v13, v13, v2
    v_sub_f32 v14, 0, v13
    v_lshlrev_b32 v16, 16, v42
    v_lshlrev_b32 v17, 16, v43
    v_mul_f32 v16, v16, v44
    v_mul_f32 v17, v17, v44
    v_mul_f32 v16, 2.0, v16
    v_mul_f32 v17, -2.0, v17
    v_cvt_pk_bf16_f32 v36, v16, v17
    v_mul_f32 v18, v16, v4
    v_mul_f32 v19, v16, v6
    v_fmac_f32 v18, v17, v5
    v_fmac_f32 v19, v17, v4
    v_cvt_pk_bf16_f32 v37, v18, v19
    ds_write2_b32 v45, v36, v37 offset0:0 offset1:68
    v_mul_f32 v20, v18, v4
    v_mul_f32 v21, v18, v6
    v_fmac_f32 v20, v19, v5
    v_fmac_f32 v21, v19, v4
    v_cvt_pk_bf16_f32 v38, v20, v21
    v_mul_f32 v22, v20, v4
    v_mul_f32 v23, v20, v6
    v_fmac_f32 v22, v21, v5
    v_fmac_f32 v23, v21, v4
    v_cvt_pk_bf16_f32 v39, v22, v23
    ds_write2_b32 v45, v38, v39 offset0:136 offset1:204
    v_mul_f32 v24, v22, v4
    v_mul_f32 v25, v22, v6
    v_fmac_f32 v24, v23, v5
    v_fmac_f32 v25, v23, v4
    v_cvt_pk_bf16_f32 v36, v24, v25
    v_mul_f32 v26, v24, v4
    v_mul_f32 v27, v24, v6
    v_fmac_f32 v26, v25, v5
    v_fmac_f32 v27, v25, v4
    v_cvt_pk_bf16_f32 v37, v26, v27
    v_add_u32 v49, 1088, v45
    ds_write2_b32 v49, v36, v37 offset0:0 offset1:68
    v_mul_f32 v28, v26, v4
    v_mul_f32 v29, v26, v6
    v_fmac_f32 v28, v27, v5
    v_fmac_f32 v29, v27, v4
    v_cvt_pk_bf16_f32 v38, v28, v29
    v_mul_f32 v30, v28, v4
    v_mul_f32 v31, v28, v6
    v_fmac_f32 v30, v29, v5
    v_fmac_f32 v31, v29, v4
    v_cvt_pk_bf16_f32 v39, v30, v31
    ds_write2_b32 v49, v38, v39 offset0:136 offset1:204
    v_mul_f32 v32, v30, v4
    v_mul_f32 v33, v30, v6
    v_fmac_f32 v32, v31, v5
    v_fmac_f32 v33, v31, v4
    v_mul_f32 v18, v16, v12
    v_mul_f32 v19, v16, v14
    v_fmac_f32 v18, v17, v13
    v_fmac_f32 v19, v17, v12
    v_cvt_pk_bf16_f32 v36, v18, v19
    v_mul_f32 v22, v20, v12
    v_mul_f32 v23, v20, v14
    v_fmac_f32 v22, v21, v13
    v_fmac_f32 v23, v21, v12
    v_cvt_pk_bf16_f32 v37, v22, v23
    v_add_u32 v49, 2176, v45
    ds_write2_b32 v49, v36, v37 offset0:0 offset1:68
    v_mul_f32 v26, v24, v12
    v_mul_f32 v27, v24, v14
    v_fmac_f32 v26, v25, v13
    v_fmac_f32 v27, v25, v12
    v_cvt_pk_bf16_f32 v38, v26, v27
    v_mul_f32 v30, v28, v12
    v_mul_f32 v31, v28, v14
    v_fmac_f32 v30, v29, v13
    v_fmac_f32 v31, v29, v12
    v_cvt_pk_bf16_f32 v39, v30, v31
    ds_write2_b32 v49, v38, v39 offset0:136 offset1:204
    v_mul_f32 v34, v32, v12
    v_mul_f32 v35, v32, v14
    v_fmac_f32 v34, v33, v13
    v_fmac_f32 v35, v33, v12
    v_cvt_pk_bf16_f32 v36, v34, v35
    v_mul_f32 v16, v18, v12
    v_mul_f32 v17, v18, v14
    v_fmac_f32 v16, v19, v13
    v_fmac_f32 v17, v19, v12
    v_cvt_pk_bf16_f32 v37, v16, v17
    v_add_u32 v49, 3264, v45
    ds_write2_b32 v49, v36, v37 offset0:0 offset1:68
    v_mul_f32 v24, v26, v12
    v_mul_f32 v25, v26, v14
    v_and_b32 v58, 31, v127
    v_lshlrev_b32 v58, 2, v58
    s_cmp_lg_u32 s63, 0
    s_cbranch_scc1 L_d0_69
    global_load_dword v59, v58, s[32:33] sc0 sc1
L_d0_69:
    s_cmp_lg_u32 s85, 1
    s_cbranch_scc1 L_utp_70
    ds_read_b32 v122, v61
    v_mov_b32 v123, s14
    s_waitcnt lgkmcnt(0)
    v_cmp_gt_u32 vcc, 2, v122
    s_cbranch_vccnz L_slow_71
L_go_72:
    ds_read_b64_tr_b16 v[106:107], v56 offset:16384
    ds_read_b64_tr_b16 v[108:109], v56 offset:18432
    ds_read_b64_tr_b16 v[110:111], v56 offset:16512
    ds_read_b64_tr_b16 v[112:113], v56 offset:18560
    ds_read_b64_tr_b16 v[114:115], v57 offset:16640
    ds_read_b64_tr_b16 v[116:117], v57 offset:18688
    ds_read_b64_tr_b16 v[118:119], v57 offset:16768
    ds_read_b64_tr_b16 v[120:121], v57 offset:18816
    ds_write_b32 v63, v123 offset:16192
    s_waitcnt lgkmcnt(1)
    buffer_store_dwordx4 v[106:109], v62, s[44:47], s12 offen offset:0 sc1
    buffer_store_dwordx4 v[110:113], v62, s[44:47], s12 offen offset:256 sc1
    buffer_store_dwordx4 v[114:117], v62, s[44:47], s12 offen offset:512 sc1
    buffer_store_dwordx4 v[118:121], v62, s[44:47], s12 offen offset:768 sc1
L_utp_70:
    v_fmac_f32 v24, v27, v13
    v_fmac_f32 v25, v27, v12
    v_cvt_pk_bf16_f32 v38, v24, v25
    v_mul_f32 v32, v34, v12
    v_mul_f32 v33, v34, v14
    v_fmac_f32 v32, v35, v13
    v_fmac_f32 v33, v35, v12
    v_cvt_pk_bf16_f32 v39, v32, v33
    ds_write2_b32 v49, v38, v39 offset0:136 offset1:204
    v_mul_f32 v18, v16, v12
    v_mul_f32 v19, v16, v14
    v_fmac_f32 v18, v17, v13
    v_fmac_f32 v19, v17, v12
    v_cvt_pk_bf16_f32 v36, v18, v19
    v_mul_f32 v26, v24, v12
    v_mul_f32 v27, v24, v14
    v_fmac_f32 v26, v25, v13
    v_fmac_f32 v27, v25, v12
    v_cvt_pk_bf16_f32 v37, v26, v27
    v_add_u32 v49, 4352, v45
    ds_write2_b32 v49, v36, v37 offset0:0 offset1:68
    v_mul_f32 v34, v32, v12
    v_mul_f32 v35, v32, v14
    v_fmac_f32 v34, v33, v13
    v_fmac_f32 v35, v33, v12
    v_cvt_pk_bf16_f32 v38, v34, v35
    v_mul_f32 v16, v18, v12
    v_mul_f32 v17, v18, v14
    v_fmac_f32 v16, v19, v13
    v_fmac_f32 v17, v19, v12
    v_cvt_pk_bf16_f32 v39, v16, v17
    ds_write2_b32 v49, v38, v39 offset0:136 offset1:204
    v_mul_f32 v32, v34, v12
    v_mul_f32 v33, v34, v14
    v_fmac_f32 v32, v35, v13
    v_fmac_f32 v33, v35, v12
    v_cvt_pk_bf16_f32 v36, v32, v33
    v_mul_f32 v18, v16, v12
    v_mul_f32 v19, v16, v14
    v_fmac_f32 v18, v17, v13
    v_fmac_f32 v19, v17, v12
    v_cvt_pk_bf16_f32 v37, v18, v19
    v_add_u32 v49, 5440, v45
    ds_write2_b32 v49, v36, v37 offset0:0 offset1:68
    v_mul_f32 v34, v32, v12
    v_mul_f32 v35, v32, v14
    v_fmac_f32 v34, v33, v13
    v_fmac_f32 v35, v33, v12
    v_cvt_pk_bf16_f32 v38, v34, v35
    v_mul_f32 v16, v18, v12
    v_mul_f32 v17, v18, v14
    v_fmac_f32 v16, v19, v13
    v_fmac_f32 v17, v19, v12
    v_cvt_pk_bf16_f32 v39, v16, v17
    ds_write2_b32 v49, v38, v39 offset0:136 offset1:204
    v_mul_f32 v32, v34, v12
    v_mul_f32 v33, v34, v14
    v_fmac_f32 v32, v35, v13
    v_fmac_f32 v33, v35, v12
    v_cvt_pk_bf16_f32 v36, v32, v33
    v_mul_f32 v18, v16, v12
    v_mul_f32 v19, v16, v14
    v_fmac_f32 v18, v17, v13
    v_fmac_f32 v19, v17, v12
    v_cvt_pk_bf16_f32 v37, v18, v19
    v_add_u32 v49, 6528, v45
    ds_write2_b32 v49, v36, v37 offset0:0 offset1:68
    v_mul_f32 v34, v32, v12
    v_mul_f32 v35, v32, v14
    v_fmac_f32 v34, v33, v13
    v_fmac_f32 v35, v33, v12
    v_cvt_pk_bf16_f32 v38, v34, v35
    v_mov_b32 v39, 0x3f80
    ds_write2_b32 v49, v38, v39 offset0:136 offset1:204
    v_cvt_pk_bf16_f32 v36, v8, v9
    v_mul_f32 v16, v8, v8
    v_mul_f32 v17, v8, v9
    v_fmac_f32 v16, v9, v10
    v_fmac_f32 v17, v9, v8
    v_cvt_pk_bf16_f32 v37, v16, v17
    v_add_u32 v49, 7616, v45
    ds_write2_b32 v49, v36, v37 offset0:0 offset1:68
    v_mul_f32 v18, v16, v8
    v_mul_f32 v19, v16, v9
    v_fmac_f32 v18, v17, v10
    v_fmac_f32 v19, v17, v8
    v_cvt_pk_bf16_f32 v38, v18, v19
    v_mul_f32 v16, v18, v8
    v_mul_f32 v17, v18, v9
    v_fmac_f32 v16, v19, v10
    v_fmac_f32 v17, v19, v8
    v_cvt_pk_bf16_f32 v39, v16, v17
    ds_write2_b32 v49, v38, v39 offset0:136 offset1:204
    v_mul_f32 v18, v16, v8
    v_mul_f32 v19, v16, v9
    v_fmac_f32 v18, v17, v10
    v_fmac_f32 v19, v17, v8
    v_cvt_pk_bf16_f32 v36, v18, v19
    v_mul_f32 v16, v18, v8
    v_mul_f32 v17, v18, v9
    v_fmac_f32 v16, v19, v10
    v_fmac_f32 v17, v19, v8
    v_cvt_pk_bf16_f32 v37, v16, v17
    v_add_u32 v49, 8704, v45
    ds_write2_b32 v49, v36, v37 offset0:0 offset1:68
    v_mul_f32 v18, v16, v8
    v_mul_f32 v19, v16, v9
    v_fmac_f32 v18, v17, v10
    v_fmac_f32 v19, v17, v8
    v_cvt_pk_bf16_f32 v38, v18, v19
    v_mul_f32 v16, v18, v8
    v_mul_f32 v17, v18, v9
    v_fmac_f32 v16, v19, v10
    v_fmac_f32 v17, v19, v8
    v_cvt_pk_bf16_f32 v39, v16, v17
    ds_write2_b32 v49, v38, v39 offset0:136 offset1:204
    v_mul_f32 v18, v16, v8
    v_mul_f32 v19, v16, v9
    v_fmac_f32 v18, v17, v10
    v_fmac_f32 v19, v17, v8
    v_cvt_pk_bf16_f32 v36, v18, v19
    v_mul_f32 v16, v18, v8
    v_mul_f32 v17, v18, v9
    v_fmac_f32 v16, v19, v10
    v_fmac_f32 v17, v19, v8
    v_cvt_pk_bf16_f32 v37, v16, v17
    v_add_u32 v49, 9792, v45
    ds_write2_b32 v49, v36, v37 offset0:0 offset1:68
    v_mul_f32 v18, v16, v8
    v_mul_f32 v19, v16, v9
    s_cmp_lg_u32 s85, 2
    s_cbranch_scc1 L_utp_74
    ds_read_b32 v122, v61
    v_mov_b32 v123, s14
    s_waitcnt lgkmcnt(0)
    v_cmp_gt_u32 vcc, 3, v122
    s_cbranch_vccnz L_slow_75
L_go_76:
    ds_read_b64_tr_b16 v[106:107], v56 offset:32768
    ds_read_b64_tr_b16 v[108:109], v56 offset:34816
    ds_read_b64_tr_b16 v[110:111], v56 offset:32896
    ds_read_b64_tr_b16 v[112:113], v56 offset:34944
    ds_read_b64_tr_b16 v[114:115], v57 offset:33024
    ds_read_b64_tr_b16 v[116:117], v57 offset:35072
    ds_read_b64_tr_b16 v[118:119], v57 offset:33152
    ds_read_b64_tr_b16 v[120:121], v57 offset:35200
    ds_write_b32 v63, v123 offset:16192
    s_waitcnt lgkmcnt(1)
    buffer_store_dwordx4 v[106:109], v62, s[44:47], s12 offen offset:0 sc1
    buffer_store_dwordx4 v[110:113], v62, s[44:47], s12 offen offset:256 sc1
    buffer_store_dwordx4 v[114:117], v62, s[44:47], s12 offen offset:512 sc1
    buffer_store_dwordx4 v[118:121], v62, s[44:47], s12 offen offset:768 sc1
L_utp_74:
    v_fmac_f32 v18, v17, v10
    v_fmac_f32 v19, v17, v8
    v_cvt_pk_bf16_f32 v38, v18, v19
    v_mul_f32 v16, v18, v8
    v_mul_f32 v17, v18, v9
    v_fmac_f32 v16, v19, v10
    v_fmac_f32 v17, v19, v8
    v_cvt_pk_bf16_f32 v39, v16, v17
    ds_write2_b32 v49, v38, v39 offset0:136 offset1:204
    v_mul_f32 v18, v16, v8
    v_mul_f32 v19, v16, v9
    v_fmac_f32 v18, v17, v10
    v_fmac_f32 v19, v17, v8
    v_cvt_pk_bf16_f32 v36, v18, v19
    v_mul_f32 v16, v18, v8
    v_mul_f32 v17, v18, v9
    v_fmac_f32 v16, v19, v10
    v_fmac_f32 v17, v19, v8
    v_cvt_pk_bf16_f32 v37, v16, v17
    v_add_u32 v49, 10880, v45
    ds_write2_b32 v49, v36, v37 offset0:0 offset1:68
    v_mul_f32 v18, v16, v8
    v_mul_f32 v19, v16, v9
    v_fmac_f32 v18, v17, v10
    v_fmac_f32 v19, v17, v8
    v_cvt_pk_bf16_f32 v38, v18, v19
    v_mul_f32 v16, v18, v8
    v_mul_f32 v17, v18, v9
    v_fmac_f32 v16, v19, v10
    v_fmac_f32 v17, v19, v8
    v_cvt_pk_bf16_f32 v39, v16, v17
    ds_write2_b32 v49, v38, v39 offset0:136 offset1:204
    v_mul_f32 v18, v16, v8
    v_mul_f32 v19, v16, v9
    v_fmac_f32 v18, v17, v10
    v_fmac_f32 v19, v17, v8
    v_cvt_pk_bf16_f32 v36, v18, v19
    v_mul_f32 v16, v18, v8
    v_mul_f32 v17, v18, v9
    v_fmac_f32 v16, v19, v10
    v_fmac_f32 v17, v19, v8
    v_cvt_pk_bf16_f32 v37, v16, v17
    v_add_u32 v49, 11968, v45
    ds_write2_b32 v49, v36, v37 offset0:0 offset1:68
    v_mul_f32 v18, v16, v8
    v_mul_f32 v19, v16, v9
    v_fmac_f32 v18, v17, v10
    v_fmac_f32 v19, v17, v8
    v_cvt_pk_bf16_f32 v38, v18, v19
    v_mul_f32 v16, v18, v8
    v_mul_f32 v17, v18, v9
    v_fmac_f32 v16, v19, v10
    v_fmac_f32 v17, v19, v8
    v_cvt_pk_bf16_f32 v39, v16, v17
    ds_write2_b32 v49, v38, v39 offset0:136 offset1:204
    v_mul_f32 v18, v16, v8
    v_mul_f32 v19, v16, v9
    v_fmac_f32 v18, v17, v10
    v_fmac_f32 v19, v17, v8
    v_cvt_pk_bf16_f32 v36, v18, v19
    v_mul_f32 v16, v18, v8
    v_mul_f32 v17, v18, v9
    v_fmac_f32 v16, v19, v10
    v_fmac_f32 v17, v19, v8
    v_cvt_pk_bf16_f32 v37, v16, v17
    v_add_u32 v49, 13056, v45
    ds_write2_b32 v49, v36, v37 offset0:0 offset1:68
    v_mul_f32 v18, v16, v8
    v_mul_f32 v19, v16, v9
    v_fmac_f32 v18, v17, v10
    v_fmac_f32 v19, v17, v8
    v_cvt_pk_bf16_f32 v38, v18, v19
    v_mul_f32 v16, v18, v8
    v_mul_f32 v17, v18, v9
    v_fmac_f32 v16, v19, v10
    v_fmac_f32 v17, v19, v8
    v_cvt_pk_bf16_f32 v39, v16, v17
    ds_write2_b32 v49, v38, v39 offset0:136 offset1:204
    v_mul_f32 v18, v16, v8
    v_mul_f32 v19, v16, v9
    v_fmac_f32 v18, v17, v10
    v_fmac_f32 v19, v17, v8
    v_cvt_pk_bf16_f32 v36, v18, v19
    v_mul_f32 v16, v18, v8
    v_mul_f32 v17, v18, v9
    v_fmac_f32 v16, v19, v10
    v_fmac_f32 v17, v19, v8
    v_cvt_pk_bf16_f32 v37, v16, v17
    v_add_u32 v49, 14144, v45
    ds_write2_b32 v49, v36, v37 offset0:0 offset1:68
    v_mul_f32 v18, v16, v8
    v_mul_f32 v19, v16, v9
    v_fmac_f32 v18, v17, v10
    v_fmac_f32 v19, v17, v8
    v_cvt_pk_bf16_f32 v38, v18, v19
    v_mul_f32 v16, v18, v8
    v_mul_f32 v17, v18, v9
    v_fmac_f32 v16, v19, v10
    v_fmac_f32 v17, v19, v8
    v_cvt_pk_bf16_f32 v39, v16, v17
    ds_write2_b32 v49, v38, v39 offset0:136 offset1:204
    v_mul_f32 v18, v16, v8
    v_mul_f32 v19, v16, v9
    v_fmac_f32 v18, v17, v10
    v_fmac_f32 v19, v17, v8
    v_cvt_pk_bf16_f32 v36, v18, v19
    v_mul_f32 v16, v18, v8
    v_mul_f32 v17, v18, v9
    v_fmac_f32 v16, v19, v10
    v_fmac_f32 v17, v19, v8
    v_cvt_pk_bf16_f32 v37, v16, v17
    v_add_u32 v49, 15232, v45
    ds_write2_b32 v49, v36, v37 offset0:0 offset1:68
    v_mul_f32 v18, v16, v8
    v_mul_f32 v19, v16, v9
    v_fmac_f32 v18, v17, v10
    v_fmac_f32 v19, v17, v8
    v_cvt_pk_bf16_f32 v38, v18, v19
    ds_write_b32 v45, v38 offset:15776
    s_cmp_lg_u32 s85, 3
    s_cbranch_scc1 L_utp_78
    ds_read_b32 v122, v61
    v_mov_b32 v123, s14
    s_waitcnt lgkmcnt(0)
    v_cmp_gt_u32 vcc, 4, v122
    s_cbranch_vccnz L_slow_79
L_go_80:
    ds_read_b64_tr_b16 v[106:107], v56 offset:0
    ds_read_b64_tr_b16 v[108:109], v56 offset:2048
    ds_read_b64_tr_b16 v[110:111], v56 offset:128
    ds_read_b64_tr_b16 v[112:113], v56 offset:2176
    ds_read_b64_tr_b16 v[114:115], v57 offset:256
    ds_read_b64_tr_b16 v[116:117], v57 offset:2304
    ds_read_b64_tr_b16 v[118:119], v57 offset:384
    ds_read_b64_tr_b16 v[120:121], v57 offset:2432
    ds_write_b32 v63, v123 offset:16192
    s_waitcnt lgkmcnt(1)
    buffer_store_dwordx4 v[106:109], v62, s[44:47], s12 offen offset:0 sc1
    buffer_store_dwordx4 v[110:113], v62, s[44:47], s12 offen offset:256 sc1
    buffer_store_dwordx4 v[114:117], v62, s[44:47], s12 offen offset:512 sc1
    buffer_store_dwordx4 v[118:121], v62, s[44:47], s12 offen offset:768 sc1
L_utp_78:
    global_load_dwordx2 v[80:81], v50, s[4:5] offset:0
    global_load_dwordx2 v[82:83], v50, s[4:5] offset:256
    global_load_dwordx2 v[84:85], v50, s[4:5] offset:512
    global_load_dwordx2 v[86:87], v50, s[4:5] offset:768
    global_load_dwordx2 v[88:89], v50, s[4:5] offset:1024
    global_load_dwordx2 v[90:91], v51, s[28:29] offset:0
    global_load_dwordx2 v[92:93], v51, s[28:29] offset:256
    global_load_dwordx2 v[94:95], v51, s[28:29] offset:512
    global_load_dwordx2 v[96:97], v51, s[28:29] offset:768
    global_load_dwordx2 v[98:99], v51, s[28:29] offset:1024
    s_waitcnt lgkmcnt(0)
    ds_read_b128 a[0:3], v46 offset:0
    ds_read_b128 a[4:7], v47 offset:0
    ds_read_b128 a[8:11], v46 offset:32
    ds_read_b128 a[12:15], v47 offset:32
    ds_read_b128 a[16:19], v46 offset:64
    ds_read_b128 a[20:23], v47 offset:64
    ds_read_b128 a[24:27], v46 offset:96
    ds_read_b128 a[28:31], v47 offset:96
    ds_read_b128 a[32:35], v46 offset:128
    ds_read_b128 a[36:39], v47 offset:128
    ds_read_b128 a[40:43], v46 offset:160
    ds_read_b128 a[44:47], v47 offset:160
    ds_read_b128 a[48:51], v46 offset:192
    ds_read_b128 a[52:55], v47 offset:192
    ds_read_b128 a[56:59], v46 offset:224
    ds_read_b128 a[60:63], v47 offset:224
    v_and_b32 v0, 0xffff0000, v40
    v_mul_f32 v1, 0x3fb8aa3b, v0
    s_mov_b32 s70, 0x3fb8aa3b
    v_fma_f32 v2, v0, s70, -v1
    v_fmac_f32 v2, 0x32a57060, v0
    s_waitcnt lgkmcnt(14)
    v_mfma_f32_32x32x16_bf16 v[64:79], a[0:3], a[4:7], 0
    v_exp_f32 v1, v1
    v_mul_f32 v2, 0x3f317218, v2
    v_fmac_f32 v1, v1, v2
    v_cvt_pk_bf16_f32 v1, v1, v1
    v_lshlrev_b32 v0, 16, v1
    s_waitcnt lgkmcnt(12)
    v_mfma_f32_32x32x16_bf16 v[64:79], a[8:11], a[12:15], v[64:79]
    v_mul_f32 v0, v0, v44
    v_mul_f32 v0, 0xbfb8aa3b, v0
    v_and_b32 v1, 0xffff0000, v41
    v_mul_f32 v1, v1, v44
    v_mul_f32 v1, 0x3e22f983, v1
    s_waitcnt lgkmcnt(10)
    v_mfma_f32_32x32x16_bf16 v[64:79], a[16:19], a[20:23], v[64:79]
    v_mul_f32 v2, 0x3f800000, v0
    v_mul_f32 v3, 0x3f800000, v1
    v_exp_f32 v2, v2
    v_fract_f32 v3, v3
    v_cos_f32 v4, v3
    s_waitcnt lgkmcnt(8)
    v_mfma_f32_32x32x16_bf16 v[64:79], a[24:27], a[28:31], v[64:79]
    v_sin_f32 v5, v3
    v_mul_f32 v4, v4, v2
    v_mul_f32 v5, v5, v2
    v_sub_f32 v6, 0, v5
    v_mul_f32 v2, 0x41000000, v0
    s_waitcnt lgkmcnt(6)
    v_mfma_f32_32x32x16_bf16 v[64:79], a[32:35], a[36:39], v[64:79]
    v_mul_f32 v3, 0x41000000, v1
    v_exp_f32 v2, v2
    v_fract_f32 v3, v3
    v_cos_f32 v8, v3
    v_sin_f32 v9, v3
    s_waitcnt lgkmcnt(4)
    v_mfma_f32_32x32x16_bf16 v[64:79], a[40:43], a[44:47], v[64:79]
    v_mul_f32 v8, v8, v2
    v_mul_f32 v9, v9, v2
    v_sub_f32 v10, 0, v9
    v_mul_f32 v2, 0x43800000, v0
    v_mul_f32 v3, 0x43800000, v1
    s_waitcnt lgkmcnt(2)
    v_mfma_f32_32x32x16_bf16 v[64:79], a[48:51], a[52:55], v[64:79]
    v_exp_f32 v2, v2
    v_fract_f32 v3, v3
    v_cos_f32 v12, v3
    v_sin_f32 v13, v3
    v_mul_f32 v12, v12, v2
    s_waitcnt lgkmcnt(0)
    v_mfma_f32_32x32x16_bf16 v[64:79], a[56:59], a[60:63], v[64:79]
    v_mul_f32 v13, v13, v2
    v_sub_f32 v14, 0, v13
    v_and_b32 v16, 0xffff0000, v42
    v_and_b32 v17, 0xffff0000, v43
    v_mul_f32 v16, v16, v44
    v_mul_f32 v17, v17, v44
    v_mul_f32 v16, 2.0, v16
    v_mul_f32 v17, -2.0, v17
    v_cvt_pk_bf16_f32 v36, v16, v17
    v_mul_f32 v18, v16, v4
    v_mul_f32 v19, v16, v6
    v_fmac_f32 v18, v17, v5
    v_fmac_f32 v19, v17, v4
    v_cvt_pk_bf16_f32 v37, v18, v19
    ds_write2_b32 v45, v36, v37 offset0:0 offset1:68
    v_mul_f32 v20, v18, v4
    v_mul_f32 v21, v18, v6
    v_fmac_f32 v20, v19, v5
    v_fmac_f32 v21, v19, v4
    v_cvt_pk_bf16_f32 v38, v20, v21
    s_waitcnt vmcnt(0)
    s_cmp_lg_u32 s63, 0
    s_cbranch_scc1 L_p0_82
    s_mov_b32 s71, 40000
L_poll_83:
    v_cmp_ne_u32 vcc, 1, v59
    s_cbranch_vccz L_ok_84
    s_sleep 8
    global_load_dword v59, v58, s[32:33] sc0 sc1
    s_sub_u32 s71, s71, 1
    s_waitcnt vmcnt(0)
    s_cbranch_scc0 L_poll_83
L_ok_84:
L_p0_82:
    v_mov_b32 v59, 99
    ds_write_b32 v63, v59 offset:16192
    v_mov_b32 v123, 114496
    ds_read_b32 v122, v123
    v_mov_b32 v52, 0
    v_mov_b32 v53, 0
    v_mov_b32 v54, 0
    v_mov_b32 v55, 0x3f803f80
    v_dot2c_f32_bf16 v52, v80, v55
    v_dot2c_f32_bf16 v53, v80, v80
    v_dot2c_f32_bf16 v54, v80, v90
    v_dot2c_f32_bf16 v52, v81, v55
    v_dot2c_f32_bf16 v53, v81, v81
    v_dot2c_f32_bf16 v54, v81, v91
    v_dot2c_f32_bf16 v52, v82, v55
    v_dot2c_f32_bf16 v53, v82, v82
    v_dot2c_f32_bf16 v54, v82, v92
    v_dot2c_f32_bf16 v52, v83, v55
    v_dot2c_f32_bf16 v53, v83, v83
    v_dot2c_f32_bf16 v54, v83, v93
    v_dot2c_f32_bf16 v52, v84, v55
    v_dot2c_f32_bf16 v53, v84, v84
    v_dot2c_f32_bf16 v54, v84, v94
    v_dot2c_f32_bf16 v52, v85, v55
    v_dot2c_f32_bf16 v53, v85, v85
    v_dot2c_f32_bf16 v54, v85, v95
    v_dot2c_f32_bf16 v52, v86, v55
    v_dot2c_f32_bf16 v53, v86, v86
    v_dot2c_f32_bf16 v54, v86, v96
    v_dot2c_f32_bf16 v52, v87, v55
    v_dot2c_f32_bf16 v53, v87, v87
    v_dot2c_f32_bf16 v54, v87, v97
    v_dot2c_f32_bf16 v52, v88, v55
    v_dot2c_f32_bf16 v53, v88, v88
    v_dot2c_f32_bf16 v54, v88, v98
    v_dot2c_f32_bf16 v52, v89, v55
    v_dot2c_f32_bf16 v53, v89, v89
    v_dot2c_f32_bf16 v54, v89, v99
    s_nop 2
    v_add_f32_dpp v52, v52, v52 row_ror:8 row_mask:0xf bank_mask:0xf
    v_add_f32_dpp v53, v53, v53 row_ror:8 row_mask:0xf bank_mask:0xf
    v_add_f32_dpp v54, v54, v54 row_ror:8 row_mask:0xf bank_mask:0xf
    v_add_f32_dpp v52, v52, v52 row_ror:4 row_mask:0xf bank_mask:0xf
    v_add_f32_dpp v53, v53, v53 row_ror:4 row_mask:0xf bank_mask:0xf
    v_add_f32_dpp v54, v54, v54 row_ror:4 row_mask:0xf bank_mask:0xf
    v_add_f32_dpp v52, v52, v52 row_ror:2 row_mask:0xf bank_mask:0xf
    v_add_f32_dpp v53, v53, v53 row_ror:2 row_mask:0xf bank_mask:0xf
    v_add_f32_dpp v54, v54, v54 row_ror:2 row_mask:0xf bank_mask:0xf
    v_add_f32_dpp v52, v52, v52 row_ror:1 row_mask:0xf bank_mask:0xf
    v_add_f32_dpp v53, v53, v53 row_ror:1 row_mask:0xf bank_mask:0xf
    v_add_f32_dpp v54, v54, v54 row_ror:1 row_mask:0xf bank_mask:0xf
    v_mov_b32 v56, v52
    s_nop 1
    v_permlane16_swap_b32 v52, v56
    v_add_f32 v52, v52, v56
    v_mov_b32 v56, v53
    s_nop 1
    v_permlane16_swap_b32 v53, v56
    v_add_f32 v53, v53, v56
    v_mov_b32 v56, v54
    s_nop 1
    v_permlane16_swap_b32 v54, v56
    v_add_f32 v54, v54, v56
    v_mul_f32 v52, 0x3acccccd, v52
    v_mul_f32 v53, 0x3acccccd, v53
    v_fma_f32 v53, -v52, v52, v53
    v_max_f32 v53, 0, v53
    v_add_f32 v53, 0x3727c5ac, v53
    v_rsq_f32 v53, v53
    v_mul_f32 v54, 0xbfb8aa3b, v54
    v_exp_f32 v54, v54
    s_nop 0
    v_add_f32 v54, 1.0, v54
    v_rcp_f32 v54, v54
    s_waitcnt lgkmcnt(0)
    v_cmp_gt_u32 vcc, 99, v122
    s_cbranch_vccnz L_slow_85
L_go_86:
    v_lshrrev_b32 v56, 5, v127
    v_lshlrev_b32 v56, 4, v56
    s_lshl_b32 s66, s61, 4
    s_add_u32 s66, s66, 16384
    s_mov_b32 exec_lo, 1
    s_mov_b32 exec_hi, 1
    buffer_store_dwordx4 v[52:55], v56, s[44:47], s66 offen sc0 sc1
    s_mov_b64 exec, -1
    v_mov_b32 v59, 1
    v_mov_b32 v126, 0
    s_mov_b64 exec, 1
    buffer_store_dword v59, v126, s[44:47], s13 offen offset:0 sc0 sc1
    s_mov_b64 exec, -1
    v_mul_f32 v22, v20, v4
    v_mul_f32 v23, v20, v6
    v_fmac_f32 v22, v21, v5
    v_fmac_f32 v23, v21, v4
    v_cvt_pk_bf16_f32 v39, v22, v23
    ds_write2_b32 v45, v38, v39 offset0:136 offset1:204
    v_mul_f32 v24, v22, v4
    v_mul_f32 v25, v22, v6
    v_fmac_f32 v24, v23, v5
    v_fmac_f32 v25, v23, v4
    v_cvt_pk_bf16_f32 v36, v24, v25
    v_mul_f32 v26, v24, v4
    v_mul_f32 v27, v24, v6
    v_fmac_f32 v26, v25, v5
    v_fmac_f32 v27, v25, v4
    v_cvt_pk_bf16_f32 v37, v26, v27
    v_add_u32 v49, 1088, v45
    ds_write2_b32 v49, v36, v37 offset0:0 offset1:68
    v_mul_f32 v28, v26, v4
    v_mul_f32 v29, v26, v6
    v_fmac_f32 v28, v27, v5
    v_fmac_f32 v29, v27, v4
    v_cvt_pk_bf16_f32 v38, v28, v29
    v_mul_f32 v30, v28, v4
    v_mul_f32 v31, v28, v6
    v_fmac_f32 v30, v29, v5
    v_fmac_f32 v31, v29, v4
    v_cvt_pk_bf16_f32 v39, v30, v31
    ds_write2_b32 v49, v38, v39 offset0:136 offset1:204
    v_mul_f32 v32, v30, v4
    v_mul_f32 v33, v30, v6
    v_fmac_f32 v32, v31, v5
    v_fmac_f32 v33, v31, v4
    v_mul_f32 v18, v16, v12
    v_mul_f32 v19, v16, v14
    v_fmac_f32 v18, v17, v13
    v_fmac_f32 v19, v17, v12
    v_cvt_pk_bf16_f32 v36, v18, v19
    v_mul_f32 v22, v20, v12
    v_mul_f32 v23, v20, v14
    v_fmac_f32 v22, v21, v13
    v_fmac_f32 v23, v21, v12
    v_cvt_pk_bf16_f32 v37, v22, v23
    v_add_u32 v49, 2176, v45
    ds_write2_b32 v49, v36, v37 offset0:0 offset1:68
    v_mul_f32 v26, v24, v12
    v_mul_f32 v27, v24, v14
    v_fmac_f32 v26, v25, v13
    v_fmac_f32 v27, v25, v12
    v_cvt_pk_bf16_f32 v38, v26, v27
    v_mul_f32 v30, v28, v12
    v_mul_f32 v31, v28, v14
    v_fmac_f32 v30, v29, v13
    v_fmac_f32 v31, v29, v12
    v_cvt_pk_bf16_f32 v39, v30, v31
    ds_write2_b32 v49, v38, v39 offset0:136 offset1:204
    v_mul_f32 v34, v32, v12
    v_mul_f32 v35, v32, v14
    v_fmac_f32 v34, v33, v13
    v_fmac_f32 v35, v33, v12
    v_cvt_pk_bf16_f32 v36, v34, v35
    v_mul_f32 v16, v18, v12
    v_mul_f32 v17, v18, v14
    v_fmac_f32 v16, v19, v13
    v_fmac_f32 v17, v19, v12
    v_cvt_pk_bf16_f32 v37, v16, v17
    v_add_u32 v49, 3264, v45
    ds_write2_b32 v49, v36, v37 offset0:0 offset1:68
    v_mul_f32 v24, v26, v12
    v_mul_f32 v25, v26, v14
    v_fmac_f32 v24, v27, v13
    v_fmac_f32 v25, v27, v12
    v_cvt_pk_bf16_f32 v38, v24, v25
    v_mul_f32 v32, v34, v12
    v_mul_f32 v33, v34, v14
    v_fmac_f32 v32, v35, v13
    v_fmac_f32 v33, v35, v12
    v_cvt_pk_bf16_f32 v39, v32, v33
    ds_write2_b32 v49, v38, v39 offset0:136 offset1:204
    v_mul_f32 v18, v16, v12
    v_mul_f32 v19, v16, v14
    v_fmac_f32 v18, v17, v13
    v_fmac_f32 v19, v17, v12
    v_cvt_pk_bf16_f32 v36, v18, v19
    v_mul_f32 v26, v24, v12
    v_mul_f32 v27, v24, v14
    v_fmac_f32 v26, v25, v13
    v_fmac_f32 v27, v25, v12
    v_cvt_pk_bf16_f32 v37, v26, v27
    v_add_u32 v49, 4352, v45
    ds_write2_b32 v49, v36, v37 offset0:0 offset1:68
    v_mul_f32 v34, v32, v12
    v_mul_f32 v35, v32, v14
    v_fmac_f32 v34, v33, v13
    v_fmac_f32 v35, v33, v12
    v_cvt_pk_bf16_f32 v38, v34, v35
    v_mul_f32 v16, v18, v12
    v_mul_f32 v17, v18, v14
    v_fmac_f32 v16, v19, v13
    v_fmac_f32 v17, v19, v12
    v_cvt_pk_bf16_f32 v39, v16, v17
    ds_write2_b32 v49, v38, v39 offset0:136 offset1:204
    v_mul_f32 v32, v34, v12
    v_mul_f32 v33, v34, v14
    v_fmac_f32 v32, v35, v13
    v_fmac_f32 v33, v35, v12
    v_cvt_pk_bf16_f32 v36, v32, v33
    v_mul_f32 v18, v16, v12
    v_mul_f32 v19, v16, v14
    v_fmac_f32 v18, v17, v13
    v_fmac_f32 v19, v17, v12
    v_cvt_pk_bf16_f32 v37, v18, v19
    v_add_u32 v49, 5440, v45
    ds_write2_b32 v49, v36, v37 offset0:0 offset1:68
    v_mul_f32 v34, v32, v12
    v_mul_f32 v35, v32, v14
    v_fmac_f32 v34, v33, v13
    v_fmac_f32 v35, v33, v12
    v_cvt_pk_bf16_f32 v38, v34, v35
    v_mul_f32 v16, v18, v12
    v_mul_f32 v17, v18, v14
    v_fmac_f32 v16, v19, v13
    v_fmac_f32 v17, v19, v12
    v_cvt_pk_bf16_f32 v39, v16, v17
    ds_write2_b32 v49, v38, v39 offset0:136 offset1:204
    v_mul_f32 v32, v34, v12
    v_mul_f32 v33, v34, v14
    v_fmac_f32 v32, v35, v13
    v_fmac_f32 v33, v35, v12
    v_cvt_pk_bf16_f32 v36, v32, v33
    v_mul_f32 v18, v16, v12
    v_mul_f32 v19, v16, v14
    v_fmac_f32 v18, v17, v13
    v_fmac_f32 v19, v17, v12
    v_cvt_pk_bf16_f32 v37, v18, v19
    v_add_u32 v49, 6528, v45
    ds_write2_b32 v49, v36, v37 offset0:0 offset1:68
    v_mul_f32 v34, v32, v12
    v_mul_f32 v35, v32, v14
    v_fmac_f32 v34, v33, v13
    v_fmac_f32 v35, v33, v12
    v_cvt_pk_bf16_f32 v38, v34, v35
    v_mov_b32 v39, 0x3f80
    ds_write2_b32 v49, v38, v39 offset0:136 offset1:204
    v_cvt_pk_bf16_f32 v36, v8, v9
    v_mul_f32 v16, v8, v8
    v_mul_f32 v17, v8, v9
    v_fmac_f32 v16, v9, v10
    v_fmac_f32 v17, v9, v8
    v_cvt_pk_bf16_f32 v37, v16, v17
    v_add_u32 v49, 7616, v45
    ds_write2_b32 v49, v36, v37 offset0:0 offset1:68
    v_mul_f32 v18, v16, v8
    v_mul_f32 v19, v16, v9
    v_fmac_f32 v18, v17, v10
    v_fmac_f32 v19, v17, v8
    v_cvt_pk_bf16_f32 v38, v18, v19
    v_mul_f32 v16, v18, v8
    v_mul_f32 v17, v18, v9
    v_fmac_f32 v16, v19, v10
    v_fmac_f32 v17, v19, v8
    v_cvt_pk_bf16_f32 v39, v16, v17
    ds_write2_b32 v49, v38, v39 offset0:136 offset1:204
    v_mul_f32 v18, v16, v8
    v_mul_f32 v19, v16, v9
    v_fmac_f32 v18, v17, v10
    v_fmac_f32 v19, v17, v8
    v_cvt_pk_bf16_f32 v36, v18, v19
    v_mul_f32 v16, v18, v8
    v_mul_f32 v17, v18, v9
    v_fmac_f32 v16, v19, v10
    v_fmac_f32 v17, v19, v8
    v_cvt_pk_bf16_f32 v37, v16, v17
    v_add_u32 v49, 8704, v45
    ds_write2_b32 v49, v36, v37 offset0:0 offset1:68
    v_mul_f32 v18, v16, v8
    v_mul_f32 v19, v16, v9
    v_fmac_f32 v18, v17, v10
    v_fmac_f32 v19, v17, v8
    v_cvt_pk_bf16_f32 v38, v18, v19
    v_mul_f32 v16, v18, v8
    v_mul_f32 v17, v18, v9
    v_fmac_f32 v16, v19, v10
    v_fmac_f32 v17, v19, v8
    v_cvt_pk_bf16_f32 v39, v16, v17
    ds_write2_b32 v49, v38, v39 offset0:136 offset1:204
    v_mul_f32 v18, v16, v8
    v_mul_f32 v19, v16, v9
    v_fmac_f32 v18, v17, v10
    v_fmac_f32 v19, v17, v8
    v_cvt_pk_bf16_f32 v36, v18, v19
    v_mul_f32 v16, v18, v8
    v_mul_f32 v17, v18, v9
    v_fmac_f32 v16, v19, v10
    v_fmac_f32 v17, v19, v8
    v_cvt_pk_bf16_f32 v37, v16, v17
    v_add_u32 v49, 9792, v45
    ds_write2_b32 v49, v36, v37 offset0:0 offset1:68
    v_mul_f32 v18, v16, v8
    v_mul_f32 v19, v16, v9
    v_fmac_f32 v18, v17, v10
    v_fmac_f32 v19, v17, v8
    v_cvt_pk_bf16_f32 v38, v18, v19
    v_mul_f32 v16, v18, v8
    v_mul_f32 v17, v18, v9
    v_fmac_f32 v16, v19, v10
    v_fmac_f32 v17, v19, v8
    v_cvt_pk_bf16_f32 v39, v16, v17
    ds_write2_b32 v49, v38, v39 offset0:136 offset1:204
    v_mul_f32 v18, v16, v8
    v_mul_f32 v19, v16, v9
    v_fmac_f32 v18, v17, v10
    v_fmac_f32 v19, v17, v8
    v_cvt_pk_bf16_f32 v36, v18, v19
    v_mul_f32 v16, v18, v8
    v_mul_f32 v17, v18, v9
    v_fmac_f32 v16, v19, v10
    v_fmac_f32 v17, v19, v8
    v_cvt_pk_bf16_f32 v37, v16, v17
    v_add_u32 v49, 10880, v45
    ds_write2_b32 v49, v36, v37 offset0:0 offset1:68
    v_mul_f32 v18, v16, v8
    v_mul_f32 v19, v16, v9
    v_fmac_f32 v18, v17, v10
    v_fmac_f32 v19, v17, v8
    v_cvt_pk_bf16_f32 v38, v18, v19
    v_mul_f32 v16, v18, v8
    v_mul_f32 v17, v18, v9
    v_fmac_f32 v16, v19, v10
    v_fmac_f32 v17, v19, v8
    v_cvt_pk_bf16_f32 v39, v16, v17
    ds_write2_b32 v49, v38, v39 offset0:136 offset1:204
    v_mul_f32 v18, v16, v8
    v_mul_f32 v19, v16, v9
    v_fmac_f32 v18, v17, v10
    v_fmac_f32 v19, v17, v8
    v_cvt_pk_bf16_f32 v36, v18, v19
    v_mul_f32 v16, v18, v8
    v_mul_f32 v17, v18, v9
    v_fmac_f32 v16, v19, v10
    v_fmac_f32 v17, v19, v8
    v_cvt_pk_bf16_f32 v37, v16, v17
    v_add_u32 v49, 11968, v45
    ds_write2_b32 v49, v36, v37 offset0:0 offset1:68
    v_mul_f32 v18, v16, v8
    v_mul_f32 v19, v16, v9
    v_fmac_f32 v18, v17, v10
    v_fmac_f32 v19, v17, v8
    v_cvt_pk_bf16_f32 v38, v18, v19
    v_mul_f32 v16, v18, v8
    v_mul_f32 v17, v18, v9
    v_fmac_f32 v16, v19, v10
    v_fmac_f32 v17, v19, v8
    v_cvt_pk_bf16_f32 v39, v16, v17
    ds_write2_b32 v49, v38, v39 offset0:136 offset1:204
    v_mul_f32 v18, v16, v8
    v_mul_f32 v19, v16, v9
    v_fmac_f32 v18, v17, v10
    v_fmac_f32 v19, v17, v8
    v_cvt_pk_bf16_f32 v36, v18, v19
    v_mul_f32 v16, v18, v8
    v_mul_f32 v17, v18, v9
    v_fmac_f32 v16, v19, v10
    v_fmac_f32 v17, v19, v8
    v_cvt_pk_bf16_f32 v37, v16, v17
    v_add_u32 v49, 13056, v45
    ds_write2_b32 v49, v36, v37 offset0:0 offset1:68
    v_mul_f32 v18, v16, v8
    v_mul_f32 v19, v16, v9
    v_fmac_f32 v18, v17, v10
    v_fmac_f32 v19, v17, v8
    v_cvt_pk_bf16_f32 v38, v18, v19
    v_mul_f32 v16, v18, v8
    v_mul_f32 v17, v18, v9
    v_fmac_f32 v16, v19, v10
    v_fmac_f32 v17, v19, v8
    v_cvt_pk_bf16_f32 v39, v16, v17
    ds_write2_b32 v49, v38, v39 offset0:136 offset1:204
    v_mul_f32 v18, v16, v8
    v_mul_f32 v19, v16, v9
    v_fmac_f32 v18, v17, v10
    v_fmac_f32 v19, v17, v8
    v_cvt_pk_bf16_f32 v36, v18, v19
    v_mul_f32 v16, v18, v8
    v_mul_f32 v17, v18, v9
    v_fmac_f32 v16, v19, v10
    v_fmac_f32 v17, v19, v8
    v_cvt_pk_bf16_f32 v37, v16, v17
    v_add_u32 v49, 14144, v45
    ds_write2_b32 v49, v36, v37 offset0:0 offset1:68
    v_mul_f32 v18, v16, v8
    v_mul_f32 v19, v16, v9
    v_fmac_f32 v18, v17, v10
    v_fmac_f32 v19, v17, v8
    v_cvt_pk_bf16_f32 v38, v18, v19
    v_mul_f32 v16, v18, v8
    v_mul_f32 v17, v18, v9
    v_fmac_f32 v16, v19, v10
    v_fmac_f32 v17, v19, v8
    v_cvt_pk_bf16_f32 v39, v16, v17
    ds_write2_b32 v49, v38, v39 offset0:136 offset1:204
    v_mul_f32 v18, v16, v8
    v_mul_f32 v19, v16, v9
    v_fmac_f32 v18, v17, v10
    v_fmac_f32 v19, v17, v8
    v_cvt_pk_bf16_f32 v36, v18, v19
    v_mul_f32 v16, v18, v8
    v_mul_f32 v17, v18, v9
    v_fmac_f32 v16, v19, v10
    v_fmac_f32 v17, v19, v8
    v_cvt_pk_bf16_f32 v37, v16, v17
    v_add_u32 v49, 15232, v45
    ds_write2_b32 v49, v36, v37 offset0:0 offset1:68
    v_mul_f32 v18, v16, v8
    v_mul_f32 v19, v16, v9
    v_fmac_f32 v18, v17, v10
    v_fmac_f32 v19, v17, v8
    v_cvt_pk_bf16_f32 v38, v18, v19
    ds_write_b32 v45, v38 offset:15776
    s_lshr_b32 s66, s62, 4
    s_lshl_b32 s66, s66, 11
    s_add_u32 s66, s66, 2965504
    v_and_b32 v51, 15, v127
    v_lshl_add_u32 v51, v51, 7, s66
    buffer_load_dword v50, v51, s[44:47], 0 offen offset:0 sc0 sc1
    s_waitcnt lgkmcnt(0)
    ds_read_b128 a[0:3], v46 offset:0
    ds_read_b128 a[4:7], v47 offset:0
    ds_read_b128 a[8:11], v46 offset:32
    ds_read_b128 a[12:15], v47 offset:32
    ds_read_b128 a[16:19], v46 offset:64
    ds_read_b128 a[20:23], v47 offset:64
    ds_read_b128 a[24:27], v46 offset:96
    ds_read_b128 a[28:31], v47 offset:96
    ds_read_b128 a[32:35], v46 offset:128
    ds_read_b128 a[36:39], v47 offset:128
    ds_read_b128 a[40:43], v46 offset:160
    ds_read_b128 a[44:47], v47 offset:160
    ds_read_b128 a[48:51], v46 offset:192
    ds_read_b128 a[52:55], v47 offset:192
    ds_read_b128 a[56:59], v46 offset:224
    ds_read_b128 a[60:63], v47 offset:224
    s_waitcnt lgkmcnt(14)
    v_mfma_f32_32x32x16_bf16 v[64:79], a[0:3], a[4:7], v[64:79]
    s_waitcnt lgkmcnt(12)
    v_mfma_f32_32x32x16_bf16 v[64:79], a[8:11], a[12:15], v[64:79]
    s_waitcnt lgkmcnt(10)
    v_mfma_f32_32x32x16_bf16 v[64:79], a[16:19], a[20:23], v[64:79]
    s_waitcnt lgkmcnt(8)
    v_mfma_f32_32x32x16_bf16 v[64:79], a[24:27], a[28:31], v[64:79]
    s_waitcnt lgkmcnt(6)
    v_mfma_f32_32x32x16_bf16 v[64:79], a[32:35], a[36:39], v[64:79]
    s_waitcnt lgkmcnt(4)
    v_mfma_f32_32x32x16_bf16 v[64:79], a[40:43], a[44:47], v[64:79]
    s_waitcnt lgkmcnt(2)
    v_mfma_f32_32x32x16_bf16 v[64:79], a[48:51], a[52:55], v[64:79]
    s_waitcnt lgkmcnt(0)
    v_mfma_f32_32x32x16_bf16 v[64:79], a[56:59], a[60:63], v[64:79]
    s_setprio 3
    s_waitcnt vmcnt(0)
    s_mov_b32 s71, 40000
L_poll_88:
    v_cmp_ne_u32 vcc, 1, v50
    s_cbranch_vccz L_ok_89
    s_sleep 4
    buffer_load_dword v50, v51, s[44:47], 0 offen offset:0 sc0 sc1
    s_sub_u32 s71, s71, 1
    s_waitcnt vmcnt(0)
    s_cbranch_scc0 L_poll_88
L_ok_89:
    s_lshr_b32 s66, s62, 2
    s_lshl_b32 s66, s66, 14
    s_add_u32 s66, s66, 131072
    v_lshrrev_b32 v50, 2, v127
    v_and_b32 v51, 3, v127
    v_lshlrev_b32 v50, 10, v50
    v_lshl_add_u32 v50, v51, 6, v50
    s_lshl_b32 s69, s63, 4
    v_add_u32 v50, s69, v50
    s_add_u32 m0, s68, 4480
    s_nop 0
    buffer_load_dwordx4 v50, s[44:47], s66 offen offset:0 sc1 lds
    s_add_u32 m0, s68, 5376
    s_nop 0
    buffer_load_dwordx4 v50, s[44:47], s66 offen offset:256 sc1 lds
    s_add_u32 m0, s68, 6272
    s_nop 0
    buffer_load_dwordx4 v50, s[44:47], s66 offen offset:512 sc1 lds
    s_add_u32 m0, s68, 7168
    s_nop 0
    buffer_load_dwordx4 v50, s[44:47], s66 offen offset:768 sc1 lds
    v_and_b32 v0, 31, v127
    v_lshrrev_b32 v1, 5, v127
    v_lshl_add_u32 v0, v0, 4, s68
    v_lshl_add_u32 v2, v1, 3, v0
    v_lshl_add_u32 v3, v1, 9, v0
    v_lshl_add_u32 v4, v1, 10, v0
    v_and_b32 v5, 15, v127
    v_lshl_add_u32 v5, v5, 3, s68
    v_lshrrev_b32 v6, 4, v127
    v_mul_u32_u24 v7, 1152, v6
    v_add_u32 v7, v7, v5
    v_mov_b32 v8, 0
    v_mov_b32 v9, 0
    ds_write_b64 v7, v[8:9] offset:4352
    ds_write_b64 v5, v[8:9]
    v_lshl_add_u32 v40, v6, 4, v5
    v_cmp_eq_u32_e64 s[16:17], 0, v127
    s_nop 1
    v_cndmask_b32_e64 v48, v126, v48, s[16:17]
    v_and_b32 v1, 1, v127
    v_cmp_eq_u32_e64 s[16:17], 0, v1
    v_add_f32 v64, v64, v48
    v_cvt_pk_bf16_f32 v8, v64, v65
    v_cvt_pk_bf16_f32 v9, v66, v67
    ds_write_b64 v2, v[8:9] offset:32
    v_cvt_pk_bf16_f32 v10, v68, v68
    v_cvt_pk_bf16_f32 v11, v69, v70
    ds_write_b64 v2, v[10:11] offset:544
    v_cvt_pk_bf16_f32 v12, v72, v72
    v_cvt_pk_bf16_f32 v13, v72, v73
    v_cvt_pk_bf16_f32 v14, v73, v73
    v_cvt_pk_bf16_f32 v15, v74, v74
    ds_write_b128 v3, v[12:15] offset:1056
    v_cndmask_b32_e64 v71, v77, v76, s[16:17]
    v_cvt_pk_bf16_f32 v16, v76, v76
    v_cvt_pk_bf16_f32 v17, v76, v76
    v_cvt_pk_bf16_f32 v18, v71, v77
    v_cvt_pk_bf16_f32 v19, v77, v77
    ds_write_b128 v4, v[16:19] offset:2080
    v_cndmask_b32_e64 v71, v79, v78, s[16:17]
    v_cvt_pk_bf16_f32 v20, v78, v78
    v_cvt_pk_bf16_f32 v21, v78, v78
    v_cvt_pk_bf16_f32 v22, v71, v79
    v_cvt_pk_bf16_f32 v23, v79, v79
    ds_write_b128 v4, v[20:23] offset:2592
    v_bfe_u32 v0, v127, 2, 2
    v_and_b32 v1, 3, v127
    v_sub_u32 v1, v1, v0
    v_lshlrev_b32 v0, 3, v6
    v_sub_u32 v1, v1, v0
    v_add_u32 v1, 28, v1
    v_lshl_add_u32 v41, v1, 3, s68
    s_waitcnt lgkmcnt(0)
    ds_read_b64_tr_b16 a[0:1], v41 offset:32
    ds_read_b64_tr_b16 a[2:3], v41 offset:0
    ds_read_b64_tr_b16 a[4:5], v41 offset:288
    ds_read_b64_tr_b16 a[6:7], v41 offset:256
    ds_read_b64_tr_b16 a[8:9], v41 offset:544
    ds_read_b64_tr_b16 a[10:11], v41 offset:512
    ds_read_b64_tr_b16 a[12:13], v41 offset:800
    ds_read_b64_tr_b16 a[14:15], v41 offset:768
    ds_read_b64_tr_b16 a[16:17], v41 offset:1056
    ds_read_b64_tr_b16 a[18:19], v41 offset:1024
    ds_read_b64_tr_b16 a[20:21], v41 offset:1312
    ds_read_b64_tr_b16 a[22:23], v41 offset:1280
    ds_read_b64_tr_b16 a[24:25], v41 offset:1568
    ds_read_b64_tr_b16 a[26:27], v41 offset:1536
    ds_read_b64_tr_b16 a[28:29], v41 offset:1824
    ds_read_b64_tr_b16 a[30:31], v41 offset:1792
    ds_read_b64_tr_b16 a[32:33], v41 offset:2080
    ds_read_b64_tr_b16 a[34:35], v41 offset:2048
    ds_read_b64_tr_b16 a[36:37], v41 offset:2336
    ds_read_b64_tr_b16 a[38:39], v41 offset:2304
    ds_read_b64_tr_b16 a[40:41], v41 offset:2592
    ds_read_b64_tr_b16 a[42:43], v41 offset:2560
    ds_read_b64_tr_b16 a[44:45], v41 offset:2848
    ds_read_b64_tr_b16 a[46:47], v41 offset:2816
    ds_read_b64_tr_b16 a[48:49], v41 offset:3104
    ds_read_b64_tr_b16 a[50:51], v41 offset:3072
    ds_read_b64_tr_b16 a[52:53], v41 offset:3360
    ds_read_b64_tr_b16 a[54:55], v41 offset:3328
    ds_read_b64_tr_b16 a[56:57], v41 offset:3616
    ds_read_b64_tr_b16 a[58:59], v41 offset:3584
    ds_read_b64_tr_b16 a[60:61], v41 offset:3872
    ds_read_b64_tr_b16 a[62:63], v41 offset:3840
    s_mov_b32 s71, 40000
L_gw:
    ds_read_b32 v51, v63 offset:16064
    s_sub_u32 s71, s71, 1
    s_cbranch_scc1 L_gwd
    s_waitcnt lgkmcnt(0)
    v_cmp_gt_u32 vcc, 12, v51
    s_cbranch_vccz L_gwd
    s_sleep 2
    s_branch L_gw
L_gwd:
    s_waitcnt vmcnt(0)
    s_waitcnt lgkmcnt(0)
    s_setprio 3
    ds_read_b64 v[0:1], v40 offset:4360
    ds_read_b64 v[2:3], v40 offset:4368
    ds_read_b64 v[4:5], v40 offset:5512
    ds_read_b64 v[6:7], v40 offset:5520
    ds_read_b64 v[8:9], v40 offset:6664
    ds_read_b64 v[10:11], v40 offset:6672
    ds_read_b64 v[12:13], v40 offset:7816
    ds_read_b64 v[14:15], v40 offset:7824
    ds_read_b64 v[16:17], v40 offset:4424
    ds_read_b64 v[18:19], v40 offset:4432
    s_waitcnt lgkmcnt(8)
    v_mfma_f32_16x16x32_bf16 a[64:67], a[4:7], v[0:3], 0
    ds_read_b64 v[20:21], v40 offset:5576
    ds_read_b64 v[22:23], v40 offset:5584
    v_mfma_f32_16x16x32_bf16 a[68:71], a[12:15], v[0:3], 0
    v_and_b32 v24, 15, v127
    v_lshrrev_b32 v25, 4, v127
    v_mfma_f32_16x16x32_bf16 a[72:75], a[20:23], v[0:3], 0
    v_bfe_u32 v26, v127, 1, 2
    v_xor_b32 v25, v25, v26
    v_mfma_f32_16x16x32_bf16 a[76:79], a[28:31], v[0:3], 0
    v_lshl_add_u32 v24, v24, 2, v25
    v_lshl_add_u32 v45, v24, 4, s68
    v_mfma_f32_16x16x32_bf16 a[80:83], a[36:39], v[0:3], 0
    v_lshl_add_u32 v24, v127, 1, 0
    v_bfe_u32 v25, v24, 3, 2
    v_mfma_f32_16x16x32_bf16 a[84:87], a[44:47], v[0:3], 0
    v_xor_b32 v24, v24, v25
    v_lshl_add_u32 v41, v24, 4, s68
    v_mfma_f32_16x16x32_bf16 a[88:91], a[52:55], v[0:3], 0
    v_lshl_add_u32 v24, v127, 1, 1
    v_bfe_u32 v25, v24, 3, 2
    v_mfma_f32_16x16x32_bf16 a[92:95], a[60:63], v[0:3], 0
    v_xor_b32 v24, v24, v25
    v_lshl_add_u32 v42, v24, 4, s68
    s_waitcnt lgkmcnt(8)
    v_mfma_f32_16x16x32_bf16 a[96:99], a[4:7], v[4:7], 0
    ds_read_b64 v[0:1], v40 offset:6728
    ds_read_b64 v[2:3], v40 offset:6736
    v_mfma_f32_16x16x32_bf16 a[100:103], a[12:15], v[4:7], 0
    v_lshl_add_u32 v24, v127, 1, -1
    v_bfe_u32 v25, v24, 3, 2
    v_mfma_f32_16x16x32_bf16 a[104:107], a[20:23], v[4:7], 0
    v_xor_b32 v24, v24, v25
    v_lshl_add_u32 v43, v24, 4, s68
    v_mfma_f32_16x16x32_bf16 a[108:111], a[28:31], v[4:7], 0
    s_lshl_b32 s66, s62, 12
    s_add_u32 s66, s66, 13631488
    v_mfma_f32_16x16x32_bf16 a[112:115], a[36:39], v[4:7], 0
    v_lshlrev_b32 v44, 4, v127
    v_cmp_eq_u32 vcc, 0, v127
    v_mfma_f32_16x16x32_bf16 a[116:119], a[44:47], v[4:7], 0
    v_add_u32 v46, 4096, v43
    v_cndmask_b32 v46, v43, v46, vcc
    v_mfma_f32_16x16x32_bf16 a[120:123], a[52:55], v[4:7], 0
    v_mfma_f32_16x16x32_bf16 a[124:127], a[60:63], v[4:7], 0
    s_waitcnt lgkmcnt(8)
    v_mfma_f32_16x16x32_bf16 v[48:51], a[4:7], v[8:11], 0
    ds_read_b64 v[4:5], v40 offset:7880
    ds_read_b64 v[6:7], v40 offset:7888
    v_mfma_f32_16x16x32_bf16 v[52:55], a[12:15], v[8:11], 0
    v_mfma_f32_16x16x32_bf16 v[56:59], a[20:23], v[8:11], 0
    v_mfma_f32_16x16x32_bf16 v[60:63], a[28:31], v[8:11], 0
    v_mfma_f32_16x16x32_bf16 v[64:67], a[36:39], v[8:11], 0
    v_mfma_f32_16x16x32_bf16 v[68:71], a[44:47], v[8:11], 0
    v_mfma_f32_16x16x32_bf16 v[72:75], a[52:55], v[8:11], 0
    v_mfma_f32_16x16x32_bf16 v[76:79], a[60:63], v[8:11], 0
    s_waitcnt lgkmcnt(8)
    v_mfma_f32_16x16x32_bf16 v[80:83], a[4:7], v[12:15], 0
    ds_read_b64 v[8:9], v40 offset:4488
    ds_read_b64 v[10:11], v40 offset:4496
    v_mfma_f32_16x16x32_bf16 v[84:87], a[12:15], v[12:15], 0
    v_mfma_f32_16x16x32_bf16 v[88:91], a[20:23], v[12:15], 0
    v_mfma_f32_16x16x32_bf16 v[92:95], a[28:31], v[12:15], 0
    v_mfma_f32_16x16x32_bf16 v[96:99], a[36:39], v[12:15], 0
    v_mfma_f32_16x16x32_bf16 v[100:103], a[44:47], v[12:15], 0
    v_mfma_f32_16x16x32_bf16 v[104:107], a[52:55], v[12:15], 0
    v_mfma_f32_16x16x32_bf16 v[108:111], a[60:63], v[12:15], 0
    s_waitcnt lgkmcnt(8)
    v_mfma_f32_16x16x32_bf16 a[64:67], a[0:3], v[16:19], a[64:67]
    ds_read_b64 v[12:13], v40 offset:5640
    ds_read_b64 v[14:15], v40 offset:5648
    v_mfma_f32_16x16x32_bf16 a[68:71], a[8:11], v[16:19], a[68:71]
    v_mfma_f32_16x16x32_bf16 a[72:75], a[16:19], v[16:19], a[72:75]
    v_mfma_f32_16x16x32_bf16 a[76:79], a[24:27], v[16:19], a[76:79]
    v_mfma_f32_16x16x32_bf16 a[80:83], a[32:35], v[16:19], a[80:83]
    v_mfma_f32_16x16x32_bf16 a[84:87], a[40:43], v[16:19], a[84:87]
    v_mfma_f32_16x16x32_bf16 a[88:91], a[48:51], v[16:19], a[88:91]
    v_mfma_f32_16x16x32_bf16 a[92:95], a[56:59], v[16:19], a[92:95]
    s_waitcnt lgkmcnt(8)
    v_mfma_f32_16x16x32_bf16 a[96:99], a[0:3], v[20:23], a[96:99]
    ds_read_b64 v[16:17], v40 offset:6792
    ds_read_b64 v[18:19], v40 offset:6800
    v_mfma_f32_16x16x32_bf16 a[100:103], a[8:11], v[20:23], a[100:103]
    v_mfma_f32_16x16x32_bf16 a[104:107], a[16:19], v[20:23], a[104:107]
    v_mfma_f32_16x16x32_bf16 a[108:111], a[24:27], v[20:23], a[108:111]
    v_mfma_f32_16x16x32_bf16 a[112:115], a[32:35], v[20:23], a[112:115]
    v_mfma_f32_16x16x32_bf16 a[116:119], a[40:43], v[20:23], a[116:119]
    v_mfma_f32_16x16x32_bf16 a[120:123], a[48:51], v[20:23], a[120:123]
    v_mfma_f32_16x16x32_bf16 a[124:127], a[56:59], v[20:23], a[124:127]
    s_waitcnt lgkmcnt(8)
    v_mfma_f32_16x16x32_bf16 v[48:51], a[0:3], v[0:3], v[48:51]
    ds_read_b64 v[20:21], v40 offset:7944
    ds_read_b64 v[22:23], v40 offset:7952
    v_mfma_f32_16x16x32_bf16 v[52:55], a[8:11], v[0:3], v[52:55]
    v_mfma_f32_16x16x32_bf16 v[56:59], a[16:19], v[0:3], v[56:59]
    v_mfma_f32_16x16x32_bf16 v[60:63], a[24:27], v[0:3], v[60:63]
    v_mfma_f32_16x16x32_bf16 v[64:67], a[32:35], v[0:3], v[64:67]
    v_mfma_f32_16x16x32_bf16 v[68:71], a[40:43], v[0:3], v[68:71]
    v_mfma_f32_16x16x32_bf16 v[72:75], a[48:51], v[0:3], v[72:75]
    v_mfma_f32_16x16x32_bf16 v[76:79], a[56:59], v[0:3], v[76:79]
    s_waitcnt lgkmcnt(8)
    v_mfma_f32_16x16x32_bf16 v[80:83], a[0:3], v[4:7], v[80:83]
    ds_read_b64 v[0:1], v40 offset:4552
    ds_read_b64 v[2:3], v40 offset:4560
    v_mfma_f32_16x16x32_bf16 v[84:87], a[8:11], v[4:7], v[84:87]
    v_mfma_f32_16x16x32_bf16 v[88:91], a[16:19], v[4:7], v[88:91]
    v_mfma_f32_16x16x32_bf16 v[92:95], a[24:27], v[4:7], v[92:95]
    v_mfma_f32_16x16x32_bf16 v[96:99], a[32:35], v[4:7], v[96:99]
    v_mfma_f32_16x16x32_bf16 v[100:103], a[40:43], v[4:7], v[100:103]
    v_mfma_f32_16x16x32_bf16 v[104:107], a[48:51], v[4:7], v[104:107]
    v_mfma_f32_16x16x32_bf16 v[108:111], a[56:59], v[4:7], v[108:111]
    s_waitcnt lgkmcnt(8)
    v_mfma_f32_16x16x32_bf16 a[68:71], a[4:7], v[8:11], a[68:71]
    ds_read_b64 v[4:5], v40 offset:5704
    ds_read_b64 v[6:7], v40 offset:5712
    v_mfma_f32_16x16x32_bf16 a[72:75], a[12:15], v[8:11], a[72:75]
    v_mfma_f32_16x16x32_bf16 a[76:79], a[20:23], v[8:11], a[76:79]
    v_accvgpr_read_b32 v24, a64
    v_accvgpr_read_b32 v28, a96
    v_mfma_f32_16x16x32_bf16 a[80:83], a[28:31], v[8:11], a[80:83]
    v_accvgpr_read_b32 v25, a65
    v_accvgpr_read_b32 v29, a97
    v_mfma_f32_16x16x32_bf16 a[84:87], a[36:39], v[8:11], a[84:87]
    v_accvgpr_read_b32 v26, a66
    v_accvgpr_read_b32 v30, a98
    v_mfma_f32_16x16x32_bf16 a[88:91], a[44:47], v[8:11], a[88:91]
    v_accvgpr_read_b32 v27, a67
    v_accvgpr_read_b32 v31, a99
    v_mfma_f32_16x16x32_bf16 a[92:95], a[52:55], v[8:11], a[92:95]
    v_add_f32 v25, v25, v28
    v_add_f32 v26, v26, v29
    s_waitcnt lgkmcnt(8)
    v_mfma_f32_16x16x32_bf16 a[100:103], a[4:7], v[12:15], a[100:103]
    ds_read_b64 v[8:9], v40 offset:6856
    ds_read_b64 v[10:11], v40 offset:6864
    v_mfma_f32_16x16x32_bf16 a[104:107], a[12:15], v[12:15], a[104:107]
    v_add_f32 v27, v27, v30
    v_add_f32 v32, v31, v50
    v_mfma_f32_16x16x32_bf16 a[108:111], a[20:23], v[12:15], a[108:111]
    v_add_f32 v26, v26, v48
    v_add_f32 v27, v27, v49
    v_mfma_f32_16x16x32_bf16 a[112:115], a[28:31], v[12:15], a[112:115]
    v_add_f32 v33, v51, v82
    v_add_f32 v27, v27, v80
    v_mfma_f32_16x16x32_bf16 a[116:119], a[36:39], v[12:15], a[116:119]
    v_add_f32 v32, v32, v81
    v_mov_b32 v34, v83
    v_mfma_f32_16x16x32_bf16 a[120:123], a[44:47], v[12:15], a[120:123]
    ds_write_b128 v45, v[24:27] offset:0
    ds_write_b128 v45, v[32:35] offset:9216
    v_mfma_f32_16x16x32_bf16 a[124:127], a[52:55], v[12:15], a[124:127]
    s_waitcnt lgkmcnt(10)
    v_mfma_f32_16x16x32_bf16 v[52:55], a[4:7], v[16:19], v[52:55]
    ds_read_b64 v[12:13], v40 offset:8008
    ds_read_b64 v[14:15], v40 offset:8016
    v_mfma_f32_16x16x32_bf16 v[56:59], a[12:15], v[16:19], v[56:59]
    v_mfma_f32_16x16x32_bf16 v[60:63], a[20:23], v[16:19], v[60:63]
    v_mfma_f32_16x16x32_bf16 v[64:67], a[28:31], v[16:19], v[64:67]
    v_mfma_f32_16x16x32_bf16 v[68:71], a[36:39], v[16:19], v[68:71]
    v_mfma_f32_16x16x32_bf16 v[72:75], a[44:47], v[16:19], v[72:75]
    v_mfma_f32_16x16x32_bf16 v[76:79], a[52:55], v[16:19], v[76:79]
    s_waitcnt lgkmcnt(10)
    v_mfma_f32_16x16x32_bf16 v[84:87], a[4:7], v[20:23], v[84:87]
    ds_read_b64 v[16:17], v40 offset:4616
    ds_read_b64 v[18:19], v40 offset:4624
    v_mfma_f32_16x16x32_bf16 v[88:91], a[12:15], v[20:23], v[88:91]
    v_mfma_f32_16x16x32_bf16 v[92:95], a[20:23], v[20:23], v[92:95]
    v_mfma_f32_16x16x32_bf16 v[96:99], a[28:31], v[20:23], v[96:99]
    v_mfma_f32_16x16x32_bf16 v[100:103], a[36:39], v[20:23], v[100:103]
    v_mfma_f32_16x16x32_bf16 v[104:107], a[44:47], v[20:23], v[104:107]
    v_mfma_f32_16x16x32_bf16 v[108:111], a[52:55], v[20:23], v[108:111]
    s_waitcnt lgkmcnt(10)
    v_mfma_f32_16x16x32_bf16 a[68:71], a[0:3], v[0:3], a[68:71]
    ds_read_b64 v[20:21], v40 offset:5768
    ds_read_b64 v[22:23], v40 offset:5776
    v_mfma_f32_16x16x32_bf16 a[72:75], a[8:11], v[0:3], a[72:75]
    v_mfma_f32_16x16x32_bf16 a[76:79], a[16:19], v[0:3], a[76:79]
    v_mfma_f32_16x16x32_bf16 a[80:83], a[24:27], v[0:3], a[80:83]
    v_mfma_f32_16x16x32_bf16 a[84:87], a[32:35], v[0:3], a[84:87]
    v_mfma_f32_16x16x32_bf16 a[88:91], a[40:43], v[0:3], a[88:91]
    v_mfma_f32_16x16x32_bf16 a[92:95], a[48:51], v[0:3], a[92:95]
    s_waitcnt lgkmcnt(10)
    v_mfma_f32_16x16x32_bf16 a[100:103], a[0:3], v[4:7], a[100:103]
    ds_read_b64 v[0:1], v40 offset:6920
    ds_read_b64 v[2:3], v40 offset:6928
    v_mfma_f32_16x16x32_bf16 a[104:107], a[8:11], v[4:7], a[104:107]
    v_mfma_f32_16x16x32_bf16 a[108:111], a[16:19], v[4:7], a[108:111]
    v_mfma_f32_16x16x32_bf16 a[112:115], a[24:27], v[4:7], a[112:115]
    v_mfma_f32_16x16x32_bf16 a[116:119], a[32:35], v[4:7], a[116:119]
    v_mfma_f32_16x16x32_bf16 a[120:123], a[40:43], v[4:7], a[120:123]
    v_mfma_f32_16x16x32_bf16 a[124:127], a[48:51], v[4:7], a[124:127]
    s_waitcnt lgkmcnt(10)
    v_mfma_f32_16x16x32_bf16 v[52:55], a[0:3], v[8:11], v[52:55]
    ds_read_b64 v[4:5], v40 offset:8072
    ds_read_b64 v[6:7], v40 offset:8080
    v_mfma_f32_16x16x32_bf16 v[56:59], a[8:11], v[8:11], v[56:59]
    v_mfma_f32_16x16x32_bf16 v[60:63], a[16:19], v[8:11], v[60:63]
    v_mfma_f32_16x16x32_bf16 v[64:67], a[24:27], v[8:11], v[64:67]
    v_mfma_f32_16x16x32_bf16 v[68:71], a[32:35], v[8:11], v[68:71]
    v_mfma_f32_16x16x32_bf16 v[72:75], a[40:43], v[8:11], v[72:75]
    v_mfma_f32_16x16x32_bf16 v[76:79], a[48:51], v[8:11], v[76:79]
    s_waitcnt lgkmcnt(8)
    v_mfma_f32_16x16x32_bf16 v[84:87], a[0:3], v[12:15], v[84:87]
    ds_read_b64 v[8:9], v40 offset:4680
    ds_read_b64 v[10:11], v40 offset:4688
    v_mfma_f32_16x16x32_bf16 v[88:91], a[8:11], v[12:15], v[88:91]
    v_mfma_f32_16x16x32_bf16 v[92:95], a[16:19], v[12:15], v[92:95]
    v_mfma_f32_16x16x32_bf16 v[96:99], a[24:27], v[12:15], v[96:99]
    v_mfma_f32_16x16x32_bf16 v[100:103], a[32:35], v[12:15], v[100:103]
    v_mfma_f32_16x16x32_bf16 v[104:107], a[40:43], v[12:15], v[104:107]
    v_mfma_f32_16x16x32_bf16 v[108:111], a[48:51], v[12:15], v[108:111]
    s_waitcnt lgkmcnt(8)
    v_mfma_f32_16x16x32_bf16 a[72:75], a[4:7], v[16:19], a[72:75]
    ds_read_b64 v[12:13], v40 offset:5832
    ds_read_b64 v[14:15], v40 offset:5840
    v_mfma_f32_16x16x32_bf16 a[76:79], a[12:15], v[16:19], a[76:79]
    v_mfma_f32_16x16x32_bf16 a[80:83], a[20:23], v[16:19], a[80:83]
    v_accvgpr_read_b32 v112, a68
    v_accvgpr_read_b32 v116, a100
    v_mfma_f32_16x16x32_bf16 a[84:87], a[28:31], v[16:19], a[84:87]
    v_accvgpr_read_b32 v113, a69
    v_accvgpr_read_b32 v117, a101
    v_mfma_f32_16x16x32_bf16 a[88:91], a[36:39], v[16:19], a[88:91]
    v_accvgpr_read_b32 v114, a70
    v_accvgpr_read_b32 v118, a102
    v_mfma_f32_16x16x32_bf16 a[92:95], a[44:47], v[16:19], a[92:95]
    v_accvgpr_read_b32 v115, a71
    v_accvgpr_read_b32 v119, a103
    s_waitcnt lgkmcnt(8)
    v_mfma_f32_16x16x32_bf16 a[104:107], a[4:7], v[20:23], a[104:107]
    ds_read_b64 v[16:17], v40 offset:6984
    ds_read_b64 v[18:19], v40 offset:6992
    v_mfma_f32_16x16x32_bf16 a[108:111], a[12:15], v[20:23], a[108:111]
    v_add_f32 v113, v113, v116
    v_add_f32 v114, v114, v117
    v_mfma_f32_16x16x32_bf16 a[112:115], a[20:23], v[20:23], a[112:115]
    v_add_f32 v115, v115, v118
    v_add_f32 v120, v119, v54
    v_mfma_f32_16x16x32_bf16 a[116:119], a[28:31], v[20:23], a[116:119]
    v_add_f32 v114, v114, v52
    v_add_f32 v115, v115, v53
    v_mfma_f32_16x16x32_bf16 a[120:123], a[36:39], v[20:23], a[120:123]
    v_add_f32 v121, v55, v86
    v_add_f32 v115, v115, v84
    v_mfma_f32_16x16x32_bf16 a[124:127], a[44:47], v[20:23], a[124:127]
    v_add_f32 v120, v120, v85
    v_mov_b32 v122, v87
    s_waitcnt lgkmcnt(8)
    v_mfma_f32_16x16x32_bf16 v[56:59], a[4:7], v[0:3], v[56:59]
    ds_read_b64 v[20:21], v40 offset:8136
    ds_read_b64 v[22:23], v40 offset:8144
    v_mfma_f32_16x16x32_bf16 v[60:63], a[12:15], v[0:3], v[60:63]
    ds_write_b128 v45, v[112:115] offset:1024
    ds_write_b128 v45, v[120:123] offset:10240
    v_mfma_f32_16x16x32_bf16 v[64:67], a[20:23], v[0:3], v[64:67]
    ds_read_b128 v[48:51], v41 offset:0
    ds_read_b128 v[80:83], v43 offset:9216
    v_mfma_f32_16x16x32_bf16 v[68:71], a[28:31], v[0:3], v[68:71]
    ds_read_b128 v[52:55], v42 offset:0
    ds_read_b128 v[84:87], v41 offset:9216
    v_mfma_f32_16x16x32_bf16 v[72:75], a[36:39], v[0:3], v[72:75]
    v_mfma_f32_16x16x32_bf16 v[76:79], a[44:47], v[0:3], v[76:79]
    s_waitcnt lgkmcnt(14)
    v_mfma_f32_16x16x32_bf16 v[88:91], a[4:7], v[4:7], v[88:91]
    ds_read_b64 v[0:1], v40 offset:4744
    ds_read_b64 v[2:3], v40 offset:4752
    v_mfma_f32_16x16x32_bf16 v[92:95], a[12:15], v[4:7], v[92:95]
    v_mfma_f32_16x16x32_bf16 v[96:99], a[20:23], v[4:7], v[96:99]
    v_mfma_f32_16x16x32_bf16 v[100:103], a[28:31], v[4:7], v[100:103]
    v_mfma_f32_16x16x32_bf16 v[104:107], a[36:39], v[4:7], v[104:107]
    v_mfma_f32_16x16x32_bf16 v[108:111], a[44:47], v[4:7], v[108:111]
    s_waitcnt lgkmcnt(2)
    v_cndmask_b32 v80, v80, v126, vcc
    v_mfma_f32_16x16x32_bf16 a[72:75], a[0:3], v[8:11], a[72:75]
    ds_read_b64 v[4:5], v40 offset:5896
    ds_read_b64 v[6:7], v40 offset:5904
    v_mfma_f32_16x16x32_bf16 a[76:79], a[8:11], v[8:11], a[76:79]
    v_cndmask_b32 v81, v81, v126, vcc
    v_cndmask_b32 v82, v82, v126, vcc
    v_mfma_f32_16x16x32_bf16 a[80:83], a[16:19], v[8:11], a[80:83]
    v_add_f32 v48, v48, v80
    v_add_f32 v49, v49, v81
    v_mfma_f32_16x16x32_bf16 a[84:87], a[24:27], v[8:11], a[84:87]
    v_add_f32 v50, v50, v82
    v_add_f32 v52, v52, v84
    v_mfma_f32_16x16x32_bf16 a[88:91], a[32:35], v[8:11], a[88:91]
    v_add_f32 v53, v53, v85
    v_add_f32 v54, v54, v86
    v_mfma_f32_16x16x32_bf16 a[92:95], a[40:43], v[8:11], a[92:95]
    v_cvt_pk_bf16_f32 v48, v48, v49
    v_cvt_pk_bf16_f32 v49, v50, v51
    v_mfma_f32_16x16x32_bf16 a[104:107], a[0:3], v[12:15], a[104:107]
    ds_read_b64 v[8:9], v40 offset:7048
    ds_read_b64 v[10:11], v40 offset:7056
    v_mfma_f32_16x16x32_bf16 a[108:111], a[8:11], v[12:15], a[108:111]
    v_cvt_pk_bf16_f32 v50, v52, v53
    v_cvt_pk_bf16_f32 v51, v54, v55
    v_mfma_f32_16x16x32_bf16 a[112:115], a[16:19], v[12:15], a[112:115]
    v_mfma_f32_16x16x32_bf16 a[116:119], a[24:27], v[12:15], a[116:119]
    v_mfma_f32_16x16x32_bf16 a[120:123], a[32:35], v[12:15], a[120:123]
    v_mfma_f32_16x16x32_bf16 a[124:127], a[40:43], v[12:15], a[124:127]
    v_mfma_f32_16x16x32_bf16 v[56:59], a[0:3], v[16:19], v[56:59]
    ds_read_b64 v[12:13], v40 offset:8200
    ds_read_b64 v[14:15], v40 offset:8208
    v_mfma_f32_16x16x32_bf16 v[60:63], a[8:11], v[16:19], v[60:63]
    v_mfma_f32_16x16x32_bf16 v[64:67], a[16:19], v[16:19], v[64:67]
    v_mfma_f32_16x16x32_bf16 v[68:71], a[24:27], v[16:19], v[68:71]
    v_mfma_f32_16x16x32_bf16 v[72:75], a[32:35], v[16:19], v[72:75]
    v_mfma_f32_16x16x32_bf16 v[76:79], a[40:43], v[16:19], v[76:79]
    v_mfma_f32_16x16x32_bf16 v[88:91], a[0:3], v[20:23], v[88:91]
    ds_read_b64 v[16:17], v40 offset:4808
    ds_read_b64 v[18:19], v40 offset:4816
    v_mfma_f32_16x16x32_bf16 v[92:95], a[8:11], v[20:23], v[92:95]
    v_mfma_f32_16x16x32_bf16 v[96:99], a[16:19], v[20:23], v[96:99]
    v_mfma_f32_16x16x32_bf16 v[100:103], a[24:27], v[20:23], v[100:103]
    v_mfma_f32_16x16x32_bf16 v[104:107], a[32:35], v[20:23], v[104:107]
    v_mfma_f32_16x16x32_bf16 v[108:111], a[40:43], v[20:23], v[108:111]
    s_waitcnt lgkmcnt(8)
    v_mfma_f32_16x16x32_bf16 a[76:79], a[4:7], v[0:3], a[76:79]
    ds_read_b64 v[20:21], v40 offset:5960
    ds_read_b64 v[22:23], v40 offset:5968
    v_mfma_f32_16x16x32_bf16 a[80:83], a[12:15], v[0:3], a[80:83]
    v_mfma_f32_16x16x32_bf16 a[84:87], a[20:23], v[0:3], a[84:87]
    v_accvgpr_read_b32 v24, a72
    v_accvgpr_read_b32 v28, a104
    v_mfma_f32_16x16x32_bf16 a[88:91], a[28:31], v[0:3], a[88:91]
    v_accvgpr_read_b32 v25, a73
    v_accvgpr_read_b32 v29, a105
    v_mfma_f32_16x16x32_bf16 a[92:95], a[36:39], v[0:3], a[92:95]
    v_accvgpr_read_b32 v26, a74
    v_accvgpr_read_b32 v30, a106
    s_waitcnt lgkmcnt(8)
    v_mfma_f32_16x16x32_bf16 a[108:111], a[4:7], v[4:7], a[108:111]
    ds_read_b64 v[0:1], v40 offset:7112
    ds_read_b64 v[2:3], v40 offset:7120
    v_mfma_f32_16x16x32_bf16 a[112:115], a[12:15], v[4:7], a[112:115]
    v_accvgpr_read_b32 v27, a75
    v_accvgpr_read_b32 v31, a107
    v_mfma_f32_16x16x32_bf16 a[116:119], a[20:23], v[4:7], a[116:119]
    v_add_f32 v25, v25, v28
    v_add_f32 v26, v26, v29
    v_mfma_f32_16x16x32_bf16 a[120:123], a[28:31], v[4:7], a[120:123]
    v_add_f32 v27, v27, v30
    v_add_f32 v32, v31, v58
    v_mfma_f32_16x16x32_bf16 a[124:127], a[36:39], v[4:7], a[124:127]
    v_add_f32 v26, v26, v56
    v_add_f32 v27, v27, v57
    s_waitcnt lgkmcnt(8)
    v_mfma_f32_16x16x32_bf16 v[60:63], a[4:7], v[8:11], v[60:63]
    ds_read_b64 v[4:5], v40 offset:8264
    ds_read_b64 v[6:7], v40 offset:8272
    v_mfma_f32_16x16x32_bf16 v[64:67], a[12:15], v[8:11], v[64:67]
    v_add_f32 v33, v59, v90
    v_add_f32 v27, v27, v88
    v_mfma_f32_16x16x32_bf16 v[68:71], a[20:23], v[8:11], v[68:71]
    v_add_f32 v32, v32, v89
    v_mov_b32 v34, v91
    v_mfma_f32_16x16x32_bf16 v[72:75], a[28:31], v[8:11], v[72:75]
    ds_write_b128 v45, v[24:27] offset:2048
    ds_write_b128 v45, v[32:35] offset:11264
    v_mfma_f32_16x16x32_bf16 v[76:79], a[36:39], v[8:11], v[76:79]
    s_waitcnt lgkmcnt(10)
    v_mfma_f32_16x16x32_bf16 v[92:95], a[4:7], v[12:15], v[92:95]
    ds_read_b64 v[8:9], v40 offset:4872
    ds_read_b64 v[10:11], v40 offset:4880
    v_mfma_f32_16x16x32_bf16 v[96:99], a[12:15], v[12:15], v[96:99]
    v_mfma_f32_16x16x32_bf16 v[100:103], a[20:23], v[12:15], v[100:103]
    v_mfma_f32_16x16x32_bf16 v[104:107], a[28:31], v[12:15], v[104:107]
    v_mfma_f32_16x16x32_bf16 v[108:111], a[36:39], v[12:15], v[108:111]
    s_waitcnt lgkmcnt(10)
    v_mfma_f32_16x16x32_bf16 a[76:79], a[0:3], v[16:19], a[76:79]
    ds_read_b64 v[12:13], v40 offset:6024
    ds_read_b64 v[14:15], v40 offset:6032
    v_mfma_f32_16x16x32_bf16 a[80:83], a[8:11], v[16:19], a[80:83]
    v_mfma_f32_16x16x32_bf16 a[84:87], a[16:19], v[16:19], a[84:87]
    v_mfma_f32_16x16x32_bf16 a[88:91], a[24:27], v[16:19], a[88:91]
    v_mfma_f32_16x16x32_bf16 a[92:95], a[32:35], v[16:19], a[92:95]
    s_waitcnt lgkmcnt(10)
    v_mfma_f32_16x16x32_bf16 a[108:111], a[0:3], v[20:23], a[108:111]
    ds_read_b64 v[16:17], v40 offset:7176
    ds_read_b64 v[18:19], v40 offset:7184
    v_mfma_f32_16x16x32_bf16 a[112:115], a[8:11], v[20:23], a[112:115]
    v_mfma_f32_16x16x32_bf16 a[116:119], a[16:19], v[20:23], a[116:119]
    v_mfma_f32_16x16x32_bf16 a[120:123], a[24:27], v[20:23], a[120:123]
    v_mfma_f32_16x16x32_bf16 a[124:127], a[32:35], v[20:23], a[124:127]
    s_waitcnt lgkmcnt(10)
    v_mfma_f32_16x16x32_bf16 v[60:63], a[0:3], v[0:3], v[60:63]
    ds_read_b64 v[20:21], v40 offset:8328
    ds_read_b64 v[22:23], v40 offset:8336
    v_mfma_f32_16x16x32_bf16 v[64:67], a[8:11], v[0:3], v[64:67]
    v_mfma_f32_16x16x32_bf16 v[68:71], a[16:19], v[0:3], v[68:71]
    v_mfma_f32_16x16x32_bf16 v[72:75], a[24:27], v[0:3], v[72:75]
    v_mfma_f32_16x16x32_bf16 v[76:79], a[32:35], v[0:3], v[76:79]
    s_waitcnt lgkmcnt(10)
    v_mfma_f32_16x16x32_bf16 v[92:95], a[0:3], v[4:7], v[92:95]
    ds_read_b64 v[0:1], v40 offset:4936
    ds_read_b64 v[2:3], v40 offset:4944
    v_mfma_f32_16x16x32_bf16 v[96:99], a[8:11], v[4:7], v[96:99]
    v_mfma_f32_16x16x32_bf16 v[100:103], a[16:19], v[4:7], v[100:103]
    v_mfma_f32_16x16x32_bf16 v[104:107], a[24:27], v[4:7], v[104:107]
    v_mfma_f32_16x16x32_bf16 v[108:111], a[32:35], v[4:7], v[108:111]
    s_waitcnt lgkmcnt(8)
    v_mfma_f32_16x16x32_bf16 a[80:83], a[4:7], v[8:11], a[80:83]
    ds_read_b64 v[4:5], v40 offset:6088
    ds_read_b64 v[6:7], v40 offset:6096
    v_mfma_f32_16x16x32_bf16 a[84:87], a[12:15], v[8:11], a[84:87]
    v_mfma_f32_16x16x32_bf16 a[88:91], a[20:23], v[8:11], a[88:91]
    v_accvgpr_read_b32 v112, a76
    v_accvgpr_read_b32 v116, a108
    v_mfma_f32_16x16x32_bf16 a[92:95], a[28:31], v[8:11], a[92:95]
    v_accvgpr_read_b32 v113, a77
    v_accvgpr_read_b32 v117, a109
    s_waitcnt lgkmcnt(8)
    v_mfma_f32_16x16x32_bf16 a[112:115], a[4:7], v[12:15], a[112:115]
    ds_read_b64 v[8:9], v40 offset:7240
    ds_read_b64 v[10:11], v40 offset:7248
    v_mfma_f32_16x16x32_bf16 a[116:119], a[12:15], v[12:15], a[116:119]
    v_accvgpr_read_b32 v114, a78
    v_accvgpr_read_b32 v118, a110
    v_mfma_f32_16x16x32_bf16 a[120:123], a[20:23], v[12:15], a[120:123]
    v_accvgpr_read_b32 v115, a79
    v_accvgpr_read_b32 v119, a111
    v_mfma_f32_16x16x32_bf16 a[124:127], a[28:31], v[12:15], a[124:127]
    v_add_f32 v113, v113, v116
    v_add_f32 v114, v114, v117
    s_waitcnt lgkmcnt(8)
    v_mfma_f32_16x16x32_bf16 v[64:67], a[4:7], v[16:19], v[64:67]
    ds_read_b64 v[12:13], v40 offset:8392
    ds_read_b64 v[14:15], v40 offset:8400
    v_mfma_f32_16x16x32_bf16 v[68:71], a[12:15], v[16:19], v[68:71]
    v_add_f32 v115, v115, v118
    v_add_f32 v120, v119, v62
    v_mfma_f32_16x16x32_bf16 v[72:75], a[20:23], v[16:19], v[72:75]
    v_add_f32 v114, v114, v60
    v_add_f32 v115, v115, v61
    v_mfma_f32_16x16x32_bf16 v[76:79], a[28:31], v[16:19], v[76:79]
    v_add_f32 v121, v63, v94
    v_add_f32 v115, v115, v92
    s_waitcnt lgkmcnt(8)
    v_mfma_f32_16x16x32_bf16 v[96:99], a[4:7], v[20:23], v[96:99]
    ds_read_b64 v[16:17], v40 offset:5000
    ds_read_b64 v[18:19], v40 offset:5008
    v_mfma_f32_16x16x32_bf16 v[100:103], a[12:15], v[20:23], v[100:103]
    v_add_f32 v120, v120, v93
    v_mov_b32 v122, v95
    v_mfma_f32_16x16x32_bf16 v[104:107], a[20:23], v[20:23], v[104:107]
    ds_write_b128 v45, v[112:115] offset:3072
    ds_write_b128 v45, v[120:123] offset:12288
    v_mfma_f32_16x16x32_bf16 v[108:111], a[28:31], v[20:23], v[108:111]
    ds_read_b128 v[56:59], v41 offset:2048
    ds_read_b128 v[88:91], v43 offset:11264
    s_waitcnt lgkmcnt(12)
    v_mfma_f32_16x16x32_bf16 a[80:83], a[0:3], v[0:3], a[80:83]
    ds_read_b64 v[20:21], v40 offset:6152
    ds_read_b64 v[22:23], v40 offset:6160
    v_mfma_f32_16x16x32_bf16 a[84:87], a[8:11], v[0:3], a[84:87]
    ds_read_b128 v[60:63], v42 offset:2048
    ds_read_b128 v[92:95], v41 offset:11264
    v_mfma_f32_16x16x32_bf16 a[88:91], a[16:19], v[0:3], a[88:91]
    v_mfma_f32_16x16x32_bf16 a[92:95], a[24:27], v[0:3], a[92:95]
    s_waitcnt lgkmcnt(14)
    v_mfma_f32_16x16x32_bf16 a[112:115], a[0:3], v[4:7], a[112:115]
    ds_read_b64 v[0:1], v40 offset:7304
    ds_read_b64 v[2:3], v40 offset:7312
    v_mfma_f32_16x16x32_bf16 a[116:119], a[8:11], v[4:7], a[116:119]
    v_mfma_f32_16x16x32_bf16 a[120:123], a[16:19], v[4:7], a[120:123]
    v_mfma_f32_16x16x32_bf16 a[124:127], a[24:27], v[4:7], a[124:127]
    s_waitcnt lgkmcnt(14)
    v_mfma_f32_16x16x32_bf16 v[64:67], a[0:3], v[8:11], v[64:67]
    ds_read_b64 v[4:5], v40 offset:8456
    ds_read_b64 v[6:7], v40 offset:8464
    v_mfma_f32_16x16x32_bf16 v[68:71], a[8:11], v[8:11], v[68:71]
    v_mfma_f32_16x16x32_bf16 v[72:75], a[16:19], v[8:11], v[72:75]
    s_waitcnt lgkmcnt(4)
    v_add_f32 v56, v56, v88
    v_mfma_f32_16x16x32_bf16 v[76:79], a[24:27], v[8:11], v[76:79]
    v_add_f32 v57, v57, v89
    v_add_f32 v58, v58, v90
    v_mfma_f32_16x16x32_bf16 v[96:99], a[0:3], v[12:15], v[96:99]
    ds_read_b64 v[8:9], v40 offset:5064
    ds_read_b64 v[10:11], v40 offset:5072
    v_mfma_f32_16x16x32_bf16 v[100:103], a[8:11], v[12:15], v[100:103]
    v_add_f32 v60, v60, v92
    v_add_f32 v61, v61, v93
    v_mfma_f32_16x16x32_bf16 v[104:107], a[16:19], v[12:15], v[104:107]
    v_add_f32 v62, v62, v94
    v_cvt_pk_bf16_f32 v56, v56, v57
    v_mfma_f32_16x16x32_bf16 v[108:111], a[24:27], v[12:15], v[108:111]
    v_cvt_pk_bf16_f32 v57, v58, v59
    v_cvt_pk_bf16_f32 v58, v60, v61
    v_mfma_f32_16x16x32_bf16 a[84:87], a[4:7], v[16:19], a[84:87]
    ds_read_b64 v[12:13], v40 offset:6216
    ds_read_b64 v[14:15], v40 offset:6224
    v_cvt_pk_bf16_f32 v59, v62, v63
    v_mfma_f32_16x16x32_bf16 a[88:91], a[12:15], v[16:19], a[88:91]
    v_accvgpr_read_b32 v24, a80
    v_mfma_f32_16x16x32_bf16 a[92:95], a[20:23], v[16:19], a[92:95]
    v_accvgpr_read_b32 v28, a112
    v_accvgpr_read_b32 v25, a81
    v_mfma_f32_16x16x32_bf16 a[116:119], a[4:7], v[20:23], a[116:119]
    ds_read_b64 v[16:17], v40 offset:7368
    ds_read_b64 v[18:19], v40 offset:7376
    v_accvgpr_read_b32 v29, a113
    v_accvgpr_read_b32 v26, a82
    v_mfma_f32_16x16x32_bf16 a[120:123], a[12:15], v[20:23], a[120:123]
    v_accvgpr_read_b32 v30, a114
    v_accvgpr_read_b32 v27, a83
    v_mfma_f32_16x16x32_bf16 a[124:127], a[20:23], v[20:23], a[124:127]
    v_accvgpr_read_b32 v31, a115
    v_add_f32 v25, v25, v28
    s_waitcnt lgkmcnt(8)
    v_mfma_f32_16x16x32_bf16 v[68:71], a[4:7], v[0:3], v[68:71]
    ds_read_b64 v[20:21], v40 offset:8520
    ds_read_b64 v[22:23], v40 offset:8528
    v_add_f32 v26, v26, v29
    v_add_f32 v27, v27, v30
    v_mfma_f32_16x16x32_bf16 v[72:75], a[12:15], v[0:3], v[72:75]
    v_add_f32 v32, v31, v66
    v_add_f32 v26, v26, v64
    v_mfma_f32_16x16x32_bf16 v[76:79], a[20:23], v[0:3], v[76:79]
    v_add_f32 v27, v27, v65
    v_add_f32 v33, v67, v98
    s_waitcnt lgkmcnt(8)
    v_mfma_f32_16x16x32_bf16 v[100:103], a[4:7], v[4:7], v[100:103]
    ds_read_b64 v[0:1], v40 offset:5128
    ds_read_b64 v[2:3], v40 offset:5136
    v_add_f32 v27, v27, v96
    v_add_f32 v32, v32, v97
    v_mfma_f32_16x16x32_bf16 v[104:107], a[12:15], v[4:7], v[104:107]
    v_mov_b32 v34, v99
    ds_write_b128 v45, v[24:27] offset:0
    v_mfma_f32_16x16x32_bf16 v[108:111], a[20:23], v[4:7], v[108:111]
    ds_write_b128 v45, v[32:35] offset:9216
    s_waitcnt lgkmcnt(10)
    v_mfma_f32_16x16x32_bf16 a[84:87], a[0:3], v[8:11], a[84:87]
    ds_read_b64 v[4:5], v40 offset:6280
    ds_read_b64 v[6:7], v40 offset:6288
    v_mfma_f32_16x16x32_bf16 a[88:91], a[8:11], v[8:11], a[88:91]
    v_mfma_f32_16x16x32_bf16 a[92:95], a[16:19], v[8:11], a[92:95]
    s_waitcnt lgkmcnt(10)
    v_mfma_f32_16x16x32_bf16 a[116:119], a[0:3], v[12:15], a[116:119]
    ds_read_b64 v[8:9], v40 offset:7432
    ds_read_b64 v[10:11], v40 offset:7440
    v_mfma_f32_16x16x32_bf16 a[120:123], a[8:11], v[12:15], a[120:123]
    v_mfma_f32_16x16x32_bf16 a[124:127], a[16:19], v[12:15], a[124:127]
    s_waitcnt lgkmcnt(10)
    v_mfma_f32_16x16x32_bf16 v[68:71], a[0:3], v[16:19], v[68:71]
    ds_read_b64 v[12:13], v40 offset:8584
    ds_read_b64 v[14:15], v40 offset:8592
    v_mfma_f32_16x16x32_bf16 v[72:75], a[8:11], v[16:19], v[72:75]
    v_mfma_f32_16x16x32_bf16 v[76:79], a[16:19], v[16:19], v[76:79]
    s_waitcnt lgkmcnt(10)
    v_mfma_f32_16x16x32_bf16 v[100:103], a[0:3], v[20:23], v[100:103]
    ds_read_b64 v[16:17], v40 offset:5192
    ds_read_b64 v[18:19], v40 offset:5200
    v_mfma_f32_16x16x32_bf16 v[104:107], a[8:11], v[20:23], v[104:107]
    v_mfma_f32_16x16x32_bf16 v[108:111], a[16:19], v[20:23], v[108:111]
    s_waitcnt lgkmcnt(10)
    v_mfma_f32_16x16x32_bf16 a[88:91], a[4:7], v[0:3], a[88:91]
    ds_read_b64 v[20:21], v40 offset:6344
    ds_read_b64 v[22:23], v40 offset:6352
    v_mfma_f32_16x16x32_bf16 a[92:95], a[12:15], v[0:3], a[92:95]
    s_waitcnt lgkmcnt(8)
    v_mfma_f32_16x16x32_bf16 a[120:123], a[4:7], v[4:7], a[120:123]
    ds_read_b64 v[0:1], v40 offset:7496
    ds_read_b64 v[2:3], v40 offset:7504
    v_accvgpr_read_b32 v112, a84
    v_accvgpr_read_b32 v116, a116
    v_mfma_f32_16x16x32_bf16 a[124:127], a[12:15], v[4:7], a[124:127]
    v_accvgpr_read_b32 v113, a85
    v_accvgpr_read_b32 v117, a117
    s_waitcnt lgkmcnt(8)
    v_mfma_f32_16x16x32_bf16 v[72:75], a[4:7], v[8:11], v[72:75]
    ds_read_b64 v[4:5], v40 offset:8648
    ds_read_b64 v[6:7], v40 offset:8656
    v_accvgpr_read_b32 v114, a86
    v_accvgpr_read_b32 v118, a118
    v_mfma_f32_16x16x32_bf16 v[76:79], a[12:15], v[8:11], v[76:79]
    v_accvgpr_read_b32 v115, a87
    v_accvgpr_read_b32 v119, a119
    s_waitcnt lgkmcnt(8)
    v_mfma_f32_16x16x32_bf16 v[104:107], a[4:7], v[12:15], v[104:107]
    ds_read_b64 v[8:9], v40 offset:5256
    ds_read_b64 v[10:11], v40 offset:5264
    v_add_f32 v113, v113, v116
    v_add_f32 v114, v114, v117
    v_mfma_f32_16x16x32_bf16 v[108:111], a[12:15], v[12:15], v[108:111]
    v_add_f32 v115, v115, v118
    v_add_f32 v120, v119, v70
    s_waitcnt lgkmcnt(8)
    v_mfma_f32_16x16x32_bf16 a[88:91], a[0:3], v[16:19], a[88:91]
    ds_read_b64 v[12:13], v40 offset:6408
    ds_read_b64 v[14:15], v40 offset:6416
    v_add_f32 v114, v114, v68
    v_add_f32 v115, v115, v69
    v_mfma_f32_16x16x32_bf16 a[92:95], a[8:11], v[16:19], a[92:95]
    v_add_f32 v121, v71, v102
    v_add_f32 v115, v115, v100
    s_waitcnt lgkmcnt(8)
    v_mfma_f32_16x16x32_bf16 a[120:123], a[0:3], v[20:23], a[120:123]
    ds_read_b64 v[16:17], v40 offset:7560
    ds_read_b64 v[18:19], v40 offset:7568
    v_add_f32 v120, v120, v101
    v_mov_b32 v122, v103
    v_mfma_f32_16x16x32_bf16 a[124:127], a[8:11], v[20:23], a[124:127]
    ds_write_b128 v45, v[112:115] offset:1024
    ds_write_b128 v45, v[120:123] offset:10240
    s_waitcnt lgkmcnt(10)
    v_mfma_f32_16x16x32_bf16 v[72:75], a[0:3], v[0:3], v[72:75]
    ds_read_b64 v[20:21], v40 offset:8712
    ds_read_b64 v[22:23], v40 offset:8720
    ds_read_b128 v[64:67], v41 offset:0
    ds_read_b128 v[96:99], v46 offset:9216
    v_mfma_f32_16x16x32_bf16 v[76:79], a[8:11], v[0:3], v[76:79]
    ds_read_b128 v[68:71], v42 offset:0
    ds_read_b128 v[100:103], v41 offset:9216
    s_waitcnt lgkmcnt(14)
    v_mfma_f32_16x16x32_bf16 v[104:107], a[0:3], v[4:7], v[104:107]
    ds_read_b64 v[0:1], v40 offset:5320
    ds_read_b64 v[2:3], v40 offset:5328
    v_mfma_f32_16x16x32_bf16 v[108:111], a[8:11], v[4:7], v[108:111]
    s_waitcnt lgkmcnt(14)
    v_mfma_f32_16x16x32_bf16 a[92:95], a[4:7], v[8:11], a[92:95]
    ds_read_b64 v[4:5], v40 offset:6472
    ds_read_b64 v[6:7], v40 offset:6480
    s_waitcnt lgkmcnt(14)
    v_mfma_f32_16x16x32_bf16 a[124:127], a[4:7], v[12:15], a[124:127]
    ds_read_b64 v[8:9], v40 offset:7624
    ds_read_b64 v[10:11], v40 offset:7632
    s_waitcnt lgkmcnt(14)
    v_mfma_f32_16x16x32_bf16 v[76:79], a[4:7], v[16:19], v[76:79]
    ds_read_b64 v[12:13], v40 offset:8776
    ds_read_b64 v[14:15], v40 offset:8784
    s_waitcnt lgkmcnt(12)
    v_mfma_f32_16x16x32_bf16 v[108:111], a[4:7], v[20:23], v[108:111]
    s_waitcnt lgkmcnt(6)
    v_mfma_f32_16x16x32_bf16 a[92:95], a[0:3], v[0:3], a[92:95]
    v_add_f32 v64, v64, v96
    s_waitcnt lgkmcnt(4)
    v_mfma_f32_16x16x32_bf16 a[124:127], a[0:3], v[4:7], a[124:127]
    v_add_f32 v65, v65, v97
    v_add_f32 v66, v66, v98
    s_waitcnt lgkmcnt(2)
    v_mfma_f32_16x16x32_bf16 v[76:79], a[0:3], v[8:11], v[76:79]
    v_add_f32 v68, v68, v100
    v_add_f32 v69, v69, v101
    s_waitcnt lgkmcnt(0)
    v_mfma_f32_16x16x32_bf16 v[108:111], a[0:3], v[12:15], v[108:111]
    v_add_f32 v70, v70, v102
    v_cvt_pk_bf16_f32 v64, v64, v65
    buffer_store_dwordx4 v[48:51], v44, s[44:47], s66 offen offset:0 sc1
    buffer_store_dwordx4 v[56:59], v44, s[44:47], s66 offen offset:1024 sc1
    v_cvt_pk_bf16_f32 v65, v66, v67
    v_cvt_pk_bf16_f32 v66, v68, v69
    v_cvt_pk_bf16_f32 v67, v70, v71
    v_accvgpr_read_b32 v24, a88
    v_accvgpr_read_b32 v28, a120
    v_accvgpr_read_b32 v25, a89
    v_accvgpr_read_b32 v29, a121
    v_accvgpr_read_b32 v26, a90
    v_accvgpr_read_b32 v30, a122
    v_accvgpr_read_b32 v27, a91
    v_accvgpr_read_b32 v31, a123
    v_add_f32 v25, v25, v28
    v_add_f32 v26, v26, v29
    v_add_f32 v27, v27, v30
    v_add_f32 v32, v31, v74
    v_add_f32 v26, v26, v72
    v_add_f32 v27, v27, v73
    v_add_f32 v33, v75, v106
    v_add_f32 v27, v27, v104
    v_add_f32 v32, v32, v105
    v_mov_b32 v34, v107
    ds_write_b128 v45, v[24:27] offset:2048
    ds_write_b128 v45, v[32:35] offset:11264
    v_accvgpr_read_b32 v112, a92
    v_accvgpr_read_b32 v116, a124
    v_accvgpr_read_b32 v113, a93
    v_accvgpr_read_b32 v117, a125
    v_accvgpr_read_b32 v114, a94
    v_accvgpr_read_b32 v118, a126
    buffer_store_dwordx4 v[64:67], v44, s[44:47], s66 offen offset:2048 sc1
    v_accvgpr_read_b32 v115, a95
    v_accvgpr_read_b32 v119, a127
    v_add_f32 v113, v113, v116
    v_add_f32 v114, v114, v117
    v_add_f32 v115, v115, v118
    v_add_f32 v120, v119, v78
    v_add_f32 v114, v114, v76
    v_add_f32 v115, v115, v77
    v_add_f32 v121, v79, v110
    v_add_f32 v115, v115, v108
    v_add_f32 v120, v120, v109
    v_mov_b32 v122, v111
    ds_write_b128 v45, v[112:115] offset:3072
    ds_write_b128 v45, v[120:123] offset:12288
    ds_read_b128 v[72:75], v41 offset:2048
    ds_read_b128 v[104:107], v43 offset:11264
    ds_read_b128 v[76:79], v42 offset:2048
    ds_read_b128 v[108:111], v41 offset:11264
    s_waitcnt lgkmcnt(0)
    v_add_f32 v72, v72, v104
    v_add_f32 v73, v73, v105
    v_add_f32 v74, v74, v106
    v_add_f32 v76, v76, v108
    v_add_f32 v77, v77, v109
    v_add_f32 v78, v78, v110
    v_cvt_pk_bf16_f32 v72, v72, v73
    v_cvt_pk_bf16_f32 v73, v74, v75
    v_cvt_pk_bf16_f32 v74, v76, v77
    v_cvt_pk_bf16_f32 v75, v78, v79
    buffer_store_dwordx4 v[72:75], v44, s[44:47], s66 offen offset:3072 sc1
    s_lshl_b32 s66, s62, 7
    s_add_u32 s66, s66, 2883584
    s_waitcnt vmcnt(0)
    v_mov_b32 v0, 1
    v_mov_b32 v1, 0
    s_mov_b64 exec, 1
    buffer_store_dword v0, v1, s[44:47], s66 offen offset:0 sc0 sc1
    s_mov_b64 exec, -1
    s_endpgm
L_slow_47:
    s_mov_b32 s71, 40000
L_sl_49:
    s_sleep 1
    ds_read_b32 v122, v61
    s_sub_u32 s71, s71, 1
    s_cbranch_scc1 L_go_48
    s_waitcnt lgkmcnt(0)
    v_cmp_gt_u32 vcc, s15, v122
    s_cbranch_vccnz L_sl_49
    s_branch L_go_48
L_slow_50:
    s_mov_b32 s71, 40000
L_sl_52:
    s_sleep 1
    ds_read_b32 v122, v61
    s_sub_u32 s71, s71, 1
    s_cbranch_scc1 L_go_51
    s_waitcnt lgkmcnt(0)
    v_cmp_gt_u32 vcc, 2, v122
    s_cbranch_vccnz L_sl_52
    s_branch L_go_51
L_slow_54:
    s_mov_b32 s71, 40000
L_sl_56:
    s_sleep 1
    ds_read_b32 v122, v61
    s_sub_u32 s71, s71, 1
    s_cbranch_scc1 L_go_55
    s_waitcnt lgkmcnt(0)
    v_cmp_gt_u32 vcc, 3, v122
    s_cbranch_vccnz L_sl_56
    s_branch L_go_55
L_slow_60:
    s_mov_b32 s71, 40000
L_sl_62:
    s_sleep 1
    ds_read_b32 v122, v123
    s_sub_u32 s71, s71, 1
    s_cbranch_scc1 L_go_61
    s_waitcnt lgkmcnt(0)
    v_cmp_gt_u32 vcc, 99, v122
    s_cbranch_vccnz L_sl_62
    s_branch L_go_61
L_slow_66:
    s_mov_b32 s71, 40000
L_sl_68:
    s_sleep 1
    ds_read_b32 v122, v61
    s_sub_u32 s71, s71, 1
    s_cbranch_scc1 L_go_67
    s_waitcnt lgkmcnt(0)
    v_cmp_gt_u32 vcc, 1, v122
    s_cbranch_vccnz L_sl_68
    s_branch L_go_67
L_slow_71:
    s_mov_b32 s71, 40000
L_sl_73:
    s_sleep 1
    ds_read_b32 v122, v61
    s_sub_u32 s71, s71, 1
    s_cbranch_scc1 L_go_72
    s_waitcnt lgkmcnt(0)
    v_cmp_gt_u32 vcc, 2, v122
    s_cbranch_vccnz L_sl_73
    s_branch L_go_72
L_slow_75:
    s_mov_b32 s71, 40000
L_sl_77:
    s_sleep 1
    ds_read_b32 v122, v61
    s_sub_u32 s71, s71, 1
    s_cbranch_scc1 L_go_76
    s_waitcnt lgkmcnt(0)
    v_cmp_gt_u32 vcc, 3, v122
    s_cbranch_vccnz L_sl_77
    s_branch L_go_76
L_slow_79:
    s_mov_b32 s71, 40000
L_sl_81:
    s_sleep 1
    ds_read_b32 v122, v61
    s_sub_u32 s71, s71, 1
    s_cbranch_scc1 L_go_80
    s_waitcnt lgkmcnt(0)
    v_cmp_gt_u32 vcc, 4, v122
    s_cbranch_vccnz L_sl_81
    s_branch L_go_80
L_slow_85:
    s_mov_b32 s71, 40000
L_sl_87:
    s_sleep 1
    ds_read_b32 v122, v123
    s_sub_u32 s71, s71, 1
    s_cbranch_scc1 L_go_86
    s_waitcnt lgkmcnt(0)
    v_cmp_gt_u32 vcc, 99, v122
    s_cbranch_vccnz L_sl_87
    s_branch L_go_86
L_end:
    s_endpgm
.section .rodata,"a"
.p2align 6
.amdhsa_kernel gated_mix__ssm_conv_s4d__mixer_channel_mlp__prompt_kernel
  .amdhsa_next_free_vgpr 256
  .amdhsa_next_free_sgpr 102
  .amdhsa_accum_offset 128
  .amdhsa_group_segment_fixed_size 0
  .amdhsa_kernarg_size 128
  .amdhsa_user_sgpr_count 2
  .amdhsa_user_sgpr_kernarg_segment_ptr 1
  .amdhsa_system_sgpr_workgroup_id_x 1
.end_amdhsa_kernel
```
